```python
import torch

def _softmax(x, axis=-1):
    return torch.softmax(x, dim=axis)
def _gelu(x):
    return torch.nn.functional.gelu(x, approximate="tanh")
def _silu(x):
    return torch.nn.functional.silu(x)
def _sigmoid(x):
    return torch.sigmoid(x)
def _layernorm(x, axis=-1, eps=1e-5):
    m = x.mean(dim=axis, keepdim=True)
    v = x.var(dim=axis, keepdim=True, unbiased=False)
    return (x - m) / torch.sqrt(v + eps)
def _scatter_add(tgt, idx, src, axis=0):
    return tgt.clone().index_add_(axis, idx, src)
def _segment_sum(src, seg, n):
    out = torch.zeros((n,) + src.shape[1:], dtype=src.dtype)
    return out.index_add_(0, seg, src)
def _pad(x, pw):
    flat = tuple(v for pair in reversed(pw) for v in pair)
    return torch.nn.functional.pad(x, flat)

kernel_name = 'standalone__mixer_token_mlp__prompt'

def setup_inputs():

    _w = (lambda a: (lambda t: t.to(torch.bfloat16) if t.is_floating_point() else t)(torch.as_tensor(a)))
    B, S, D, F = 1, 2048, 640, 1728
    return {
        "x": _w((lambda *s: torch.randn(*s, dtype=torch.bfloat16) * 0.05)(B, S, D)),
        "w1": _w((lambda *s: torch.randn(*s, dtype=torch.bfloat16) * 0.2)(S, F) * (S ** -0.5)),
        "b1": _w((lambda *s: torch.randn(*s, dtype=torch.bfloat16) * 1.6)(F) * 0.02),
        "w2": _w((lambda *s: torch.randn(*s, dtype=torch.bfloat16) * 0.05)(F, S) * (F ** -0.5)),
        "b2": _w((lambda *s: torch.randn(*s, dtype=torch.bfloat16) * 0.1)(S) * 0.02),
    }

def reference(x, w1, b1, w2, b2):
    B, S, D = x.shape
    h = _layernorm(x, axis=-1)
    u = torch.einsum("bsd,sf->bdf", h, w1) + b1
    u = _gelu(u)
    y = torch.einsum("bdf,fs->bds", u, w2) + b2
    return (lambda x, *d: x.permute(*d))(y, 0, 2, 1)
```

```asm
; @launch grid=(256,1,1) block=(256,1,1) lds=163840
.amdgcn_target "amdgcn-amd-amdhsa--gfx950"
.text
.globl standalone__mixer_token_mlp__prompt_kernel
.p2align 8
.type standalone__mixer_token_mlp__prompt_kernel,@function
standalone__mixer_token_mlp__prompt_kernel:
    s_getpc_b64 s[94:95]
    s_cmp_ge_u32 s2, 256
    s_cbranch_scc1 L_done
    s_load_dwordx16 s[4:19], s[0:1], 0
    s_memrealtime s[96:97]
    v_lshrrev_b32 v15, 6, v0
    v_and_b32 v1, 63, v0
    v_readfirstlane_b32 s60, v15
    s_and_b32 s61, s2, 7
    s_lshr_b32 s62, s2, 3
    s_add_u32 s69, s61, 0
    s_and_b32 s69, s69, 3
    s_and_b32 s70, s61, 4
    s_mul_i32 s68, s69, 7
    s_lshr_b32 s63, s62, 2
    s_add_u32 s63, s63, s68
    s_and_b32 s71, s62, 3
    s_add_u32 s64, s70, s71
    s_lshl_b32 s74, s64, 1
    s_cmp_eq_u32 s69, 3
    s_cselect_b32 s100, 24, 28
    s_lshl_b32 s68, s61, 2
    s_sub_u32 s68, s68, 28
    s_lshl_b32 s71, s61, 3
    s_sub_u32 s71, s71, 48
    s_cselect_b32 s101, s68, s68
    s_cmp_ge_u32 s61, 6
    s_cselect_b32 s101, s71, s68
    s_add_u32 s101, s101, s62
    s_lshr_b32 s68, s62, 3
    s_lshl_b32 s65, s61, 2
    s_add_u32 s65, s65, s68
    s_and_b32 s66, s62, 7
    s_mul_i32 s75, s66, 7
    s_lshr_b32 s75, s75, 2
    s_lshl_b32 s78, s60, 15
    s_lshl_b32 s99, s60, 13
    s_add_u32 s99, s99, 131072
    v_lshrrev_b32 v15, 3, v1
    v_lshrrev_b32 v9, 1, v15
    v_lshlrev_b32 v9, 1, v9
    v_and_b32 v220, 7, v1
    v_xor_b32 v220, v220, v9
    v_lshlrev_b32 v220, 4, v220
    v_mul_u32_u24 v15, 3456, v15
    v_add_u32 v220, v220, v15
    s_lshl_b32 s68, s63, 7
    v_add_u32 v220, s68, v220
    v_add_u32 v221, 26624, v220
    v_add_u32 v222, 53248, v220
    v_add_u32 v223, 79872, v220
    s_mul_i32 s3, s60, 1769472
    s_lshr_b32 s68, s2, 2
    s_and_b32 s69, s2, 3
    s_lshl_b32 s70, s68, 5
    s_lshr_b32 s71, s60, 1
    s_lshl_b32 s71, s71, 4
    s_add_u32 s70, s70, s71
    s_lshl_b32 s71, s69, 2
    s_add_u32 s70, s70, s71
    s_and_b32 s71, s60, 1
    s_lshl_b32 s71, s71, 1
    s_add_u32 s70, s70, s71
    s_mul_i32 s70, s70, 1280
    v_lshrrev_b32 v130, 5, v1
    v_and_b32 v131, 31, v1
    v_lshlrev_b32 v131, 3, v131
    v_mul_u32_u24 v132, 1280, v130
    v_add_u32 v132, v132, v131
    v_mov_b32 v15, 0
    s_waitcnt lgkmcnt(0)
    s_mov_b32 s56, s16
    s_and_b32 s57, s17, 0xffff
    s_mov_b32 s58, 256
    s_mov_b32 s59, 0x20000
    s_cmp_lg_u32 s2, 0
    s_cbranch_scc1 L_nononce
    s_cmp_lg_u32 s60, 3
    s_cbranch_scc1 L_nononce
    s_or_b32 s67, s96, 1
    v_mov_b32 v9, s67
    s_mov_b64 s[82:83], exec
    s_mov_b64 exec, 1
    buffer_store_dword v9, v15, s[56:59], 0 offen sc1
    s_mov_b64 exec, s[82:83]
L_nononce:
    s_mov_b32 s20, s4
    s_and_b32 s21, s5, 0xffff
    s_mov_b32 s22, 2621440
    s_mov_b32 s23, 0x20000
    buffer_load_dwordx2 v[96:97], v132, s[20:23], s70 offen offset:0 nt
    buffer_load_dwordx2 v[98:99], v132, s[20:23], s70 offen offset:256 nt
    buffer_load_dwordx2 v[100:101], v132, s[20:23], s70 offen offset:512 nt
    buffer_load_dwordx2 v[102:103], v132, s[20:23], s70 offen offset:768 nt
    buffer_load_dwordx2 v[104:105], v132, s[20:23], s70 offen offset:1024 nt
    s_mov_b32 s24, s6
    s_and_b32 s25, s7, 0xffff
    s_mov_b32 s26, 7077888
    s_mov_b32 s27, 0x20000
    s_barrier
    s_cmp_ge_u32 s62, s100
    s_cbranch_scc1 L_ln_now1
    s_add_u32 m0, s78, 0
    s_add_u32 s72, s74, 0
    s_cmp_ge_u32 s72, 16
    s_cselect_b32 s77, 16, 0
    s_sub_u32 s72, s72, s77
    s_mul_i32 s72, s72, 110592
    s_add_u32 s77, s72, s3
    buffer_load_dwordx4 v220, s[24:27], s77 offen offset:0  lds
    buffer_load_dwordx4 v221, s[24:27], s77 offen offset:1024  lds
    buffer_load_dwordx4 v222, s[24:27], s77 offen offset:2048  lds
    buffer_load_dwordx4 v223, s[24:27], s77 offen offset:3072  lds
    s_add_u32 m0, s78, 4096
    s_add_u32 s72, s74, 1
    s_cmp_ge_u32 s72, 16
    s_cselect_b32 s77, 16, 0
    s_sub_u32 s72, s72, s77
    s_mul_i32 s72, s72, 110592
    s_add_u32 s77, s72, s3
    buffer_load_dwordx4 v220, s[24:27], s77 offen offset:0  lds
    buffer_load_dwordx4 v221, s[24:27], s77 offen offset:1024  lds
    buffer_load_dwordx4 v222, s[24:27], s77 offen offset:2048  lds
    buffer_load_dwordx4 v223, s[24:27], s77 offen offset:3072  lds
L_ln_now1:
    s_cmp_lg_u32 s60, 3
    s_cbranch_scc1 L_nocpf
    s_lshl_b32 s71, s62, 11
    v_lshlrev_b32 v216, 4, v1
    v_add_u32 v216, s71, v216
    v_add_u32 v217, 1024, v216
    v_min_u32 v216, L_codeend-standalone__mixer_token_mlp__prompt_kernel-36, v216
    global_load_dwordx4 v[240:243], v216, s[94:95]
    v_min_u32 v217, L_codeend-standalone__mixer_token_mlp__prompt_kernel-36, v217
    global_load_dwordx4 v[244:247], v217, s[94:95]
L_nocpf:
    s_mov_b32 s32, s18
    s_and_b32 s33, s19, 0xffff
    s_mov_b32 s34, 2621440
    s_mov_b32 s35, 0x20000
    s_add_u32 s44, s18, 6291456
    s_addc_u32 s45, s19, 0
    s_and_b32 s45, s45, 0xffff
    s_mov_b32 s46, 262144
    s_mov_b32 s47, 0x20000
    s_mul_i32 s76, s68, 40960
    s_lshl_b32 s69, s69, 8
    s_add_u32 s76, s76, s69
    s_lshl_b32 s71, s60, 1
    v_add_u32 v134, s71, v130
    v_mul_u32_u24 v134, 1344, v134
    v_add_u32 v134, v134, v131
    v_add_u32 v134, 131072, v134
    s_mul_i32 s71, s60, 12
    s_cmp_eq_u32 s60, 3
    s_cselect_b32 s71, 32, s71
    v_lshrrev_b32 v136, 4, v1
    v_add_u32 v136, s71, v136
    v_bfe_u32 v135, v1, 2, 2
    v_mul_u32_u24 v135, 1344, v135
    v_lshlrev_b32 v137, 5, v136
    v_add_u32 v135, v135, v137
    v_and_b32 v137, 3, v1
    v_lshlrev_b32 v137, 3, v137
    v_add_u32 v135, v135, v137
    v_add_u32 v135, 131072, v135
    v_lshlrev_b32 v136, 10, v136
    v_and_b32 v137, 15, v1
    v_lshlrev_b32 v137, 4, v137
    v_add_u32 v136, v136, v137
    v_lshrrev_b32 v216, 4, v1
    v_and_b32 v217, 1, v216
    v_lshlrev_b32 v217, 2, v217
    v_bfe_u32 v218, v1, 2, 2
    v_add_u32 v217, v217, v218
    v_lshrrev_b32 v216, 1, v216
    v_lshlrev_b32 v216, 10, v216
    v_lshlrev_b32 v218, 7, v217
    v_add_u32 v216, v216, v218
    v_and_b32 v218, 3, v1
    v_lshlrev_b32 v218, 3, v218
    v_add_u32 v216, v216, v218
    v_add_u32 v216, s78, v216
    v_lshrrev_b32 v217, 1, v217
    v_xor_b32 v218, 0, v217
    v_lshlrev_b32 v218, 5, v218
    v_add_u32 v2, v216, v218
    v_xor_b32 v218, 1, v217
    v_lshlrev_b32 v218, 5, v218
    v_add_u32 v3, v216, v218
    v_xor_b32 v218, 2, v217
    v_lshlrev_b32 v218, 5, v218
    v_add_u32 v4, v216, v218
    v_xor_b32 v218, 3, v217
    v_lshlrev_b32 v218, 5, v218
    v_add_u32 v5, v216, v218
    s_mov_b32 s68, 0xffff0000
    s_cmp_ge_u32 s62, s100
    s_cbranch_scc1 L_ln_idle
    s_cmp_eq_u32 s60, 3
    s_cbranch_scc1 L_ln_w3
    s_waitcnt vmcnt(8)
    s_branch L_ln_go
L_ln_w3:
    s_waitcnt vmcnt(10)
    s_branch L_ln_go
L_ln_idle:
    s_cmp_eq_u32 s60, 3
    s_cbranch_scc1 L_ln_idle3
    s_waitcnt vmcnt(0)
    s_branch L_ln_go
L_ln_idle3:
    s_waitcnt vmcnt(2)
L_ln_go:
    v_lshlrev_b32 v108, 16, v96
    v_and_b32 v109, s68, v96
    v_lshlrev_b32 v110, 16, v97
    v_and_b32 v111, s68, v97
    v_lshlrev_b32 v112, 16, v98
    v_and_b32 v113, s68, v98
    v_lshlrev_b32 v114, 16, v99
    v_and_b32 v115, s68, v99
    v_lshlrev_b32 v116, 16, v100
    v_and_b32 v117, s68, v100
    v_lshlrev_b32 v118, 16, v101
    v_and_b32 v119, s68, v101
    v_lshlrev_b32 v120, 16, v102
    v_and_b32 v121, s68, v102
    v_lshlrev_b32 v122, 16, v103
    v_and_b32 v123, s68, v103
    v_lshlrev_b32 v124, 16, v104
    v_and_b32 v125, s68, v104
    v_lshlrev_b32 v126, 16, v105
    v_and_b32 v127, s68, v105
    v_pk_add_f32 v[138:139], v[108:109], v[112:113]
    v_pk_add_f32 v[140:141], v[110:111], v[114:115]
    v_pk_add_f32 v[138:139], v[138:139], v[116:117]
    v_pk_add_f32 v[140:141], v[140:141], v[118:119]
    v_pk_add_f32 v[138:139], v[138:139], v[120:121]
    v_pk_add_f32 v[140:141], v[140:141], v[122:123]
    v_pk_add_f32 v[138:139], v[138:139], v[124:125]
    v_pk_add_f32 v[140:141], v[140:141], v[126:127]
    v_pk_add_f32 v[138:139], v[138:139], v[140:141]
    v_add_f32 v142, v138, v139
    s_nop 1
    v_add_f32_dpp v142, v142, v142 row_ror:8 row_mask:0xf bank_mask:0xf
    s_nop 1
    v_add_f32_dpp v142, v142, v142 row_ror:4 row_mask:0xf bank_mask:0xf
    s_nop 1
    v_add_f32_dpp v142, v142, v142 row_ror:2 row_mask:0xf bank_mask:0xf
    s_nop 1
    v_add_f32_dpp v142, v142, v142 row_ror:1 row_mask:0xf bank_mask:0xf
    v_mov_b32 v138, v142
    s_nop 1
    v_permlane16_swap_b32 v142, v138
    s_nop 1
    v_add_f32 v142, v142, v138
    v_mul_f32 v142, 0x3acccccd, v142
    v_mov_b32 v143, v142
    v_pk_add_f32 v[108:109], v[108:109], v[142:143] neg_lo:[0,1] neg_hi:[0,1]
    v_pk_add_f32 v[110:111], v[110:111], v[142:143] neg_lo:[0,1] neg_hi:[0,1]
    v_pk_add_f32 v[112:113], v[112:113], v[142:143] neg_lo:[0,1] neg_hi:[0,1]
    v_pk_add_f32 v[114:115], v[114:115], v[142:143] neg_lo:[0,1] neg_hi:[0,1]
    v_pk_add_f32 v[116:117], v[116:117], v[142:143] neg_lo:[0,1] neg_hi:[0,1]
    v_pk_add_f32 v[118:119], v[118:119], v[142:143] neg_lo:[0,1] neg_hi:[0,1]
    v_pk_add_f32 v[120:121], v[120:121], v[142:143] neg_lo:[0,1] neg_hi:[0,1]
    v_pk_add_f32 v[122:123], v[122:123], v[142:143] neg_lo:[0,1] neg_hi:[0,1]
    v_pk_add_f32 v[124:125], v[124:125], v[142:143] neg_lo:[0,1] neg_hi:[0,1]
    v_pk_add_f32 v[126:127], v[126:127], v[142:143] neg_lo:[0,1] neg_hi:[0,1]
    v_pk_mul_f32 v[138:139], v[108:109], v[108:109]
    v_pk_mul_f32 v[140:141], v[110:111], v[110:111]
    v_pk_fma_f32 v[138:139], v[112:113], v[112:113], v[138:139]
    v_pk_fma_f32 v[140:141], v[114:115], v[114:115], v[140:141]
    v_pk_fma_f32 v[138:139], v[116:117], v[116:117], v[138:139]
    v_pk_fma_f32 v[140:141], v[118:119], v[118:119], v[140:141]
    v_pk_fma_f32 v[138:139], v[120:121], v[120:121], v[138:139]
    v_pk_fma_f32 v[140:141], v[122:123], v[122:123], v[140:141]
    v_pk_fma_f32 v[138:139], v[124:125], v[124:125], v[138:139]
    v_pk_fma_f32 v[140:141], v[126:127], v[126:127], v[140:141]
    v_pk_add_f32 v[138:139], v[138:139], v[140:141]
    v_add_f32 v142, v138, v139
    s_nop 1
    v_add_f32_dpp v142, v142, v142 row_ror:8 row_mask:0xf bank_mask:0xf
    s_nop 1
    v_add_f32_dpp v142, v142, v142 row_ror:4 row_mask:0xf bank_mask:0xf
    s_nop 1
    v_add_f32_dpp v142, v142, v142 row_ror:2 row_mask:0xf bank_mask:0xf
    s_nop 1
    v_add_f32_dpp v142, v142, v142 row_ror:1 row_mask:0xf bank_mask:0xf
    v_mov_b32 v138, v142
    s_nop 1
    v_permlane16_swap_b32 v142, v138
    s_nop 1
    v_add_f32 v142, v142, v138
    v_mov_b32 v143, 0x3727c5ac
    v_fmac_f32 v143, 0x3acccccd, v142
    v_rsq_f32 v142, v143
    s_nop 0
    v_mov_b32 v143, v142
    v_pk_mul_f32 v[108:109], v[108:109], v[142:143]
    v_pk_mul_f32 v[110:111], v[110:111], v[142:143]
    v_pk_mul_f32 v[112:113], v[112:113], v[142:143]
    v_pk_mul_f32 v[114:115], v[114:115], v[142:143]
    v_pk_mul_f32 v[116:117], v[116:117], v[142:143]
    v_pk_mul_f32 v[118:119], v[118:119], v[142:143]
    v_pk_mul_f32 v[120:121], v[120:121], v[142:143]
    v_pk_mul_f32 v[122:123], v[122:123], v[142:143]
    v_pk_mul_f32 v[124:125], v[124:125], v[142:143]
    v_pk_mul_f32 v[126:127], v[126:127], v[142:143]
    v_cvt_pk_bf16_f32 v96, v108, v109
    v_cvt_pk_bf16_f32 v97, v110, v111
    v_cvt_pk_bf16_f32 v98, v112, v113
    v_cvt_pk_bf16_f32 v99, v114, v115
    v_cvt_pk_bf16_f32 v100, v116, v117
    v_cvt_pk_bf16_f32 v101, v118, v119
    v_cvt_pk_bf16_f32 v102, v120, v121
    v_cvt_pk_bf16_f32 v103, v122, v123
    v_cvt_pk_bf16_f32 v104, v124, v125
    v_cvt_pk_bf16_f32 v105, v126, v127
    ds_write_b64 v134, v[96:97] offset:0
    ds_write_b64 v134, v[98:99] offset:256
    ds_write_b64 v134, v[100:101] offset:512
    ds_write_b64 v134, v[102:103] offset:768
    ds_write_b64 v134, v[104:105] offset:1024
    s_waitcnt lgkmcnt(0)
    s_barrier
    ds_read_b64_tr_b16 v[108:109], v135 offset:0
    ds_read_b64_tr_b16 v[110:111], v135 offset:5376
    ds_read_b64_tr_b16 v[112:113], v135 offset:128
    ds_read_b64_tr_b16 v[114:115], v135 offset:5504
    s_cmp_ge_u32 s60, 2
    s_cbranch_scc1 L_ln_two
    ds_read_b64_tr_b16 v[116:117], v135 offset:256
    ds_read_b64_tr_b16 v[118:119], v135 offset:5632
    s_waitcnt lgkmcnt(0)
    s_add_u32 s68, s76, 8192
    buffer_store_dwordx4 v[116:119], v136, s[32:35], s68 offen sc1
L_ln_two:
    s_waitcnt lgkmcnt(0)
    s_add_u32 s68, s76, 0
    buffer_store_dwordx4 v[108:111], v136, s[32:35], s68 offen sc1
    s_add_u32 s68, s76, 4096
    buffer_store_dwordx4 v[112:115], v136, s[32:35], s68 offen sc1
    buffer_load_dword v214, v15, s[56:59], 0 offen sc1
    s_cmp_ge_u32 s62, s100
    s_cbranch_scc1 L_ln_idle2
    s_add_u32 m0, s78, 8192
    s_add_u32 s72, s74, 2
    s_cmp_ge_u32 s72, 16
    s_cselect_b32 s77, 16, 0
    s_sub_u32 s72, s72, s77
    s_mul_i32 s72, s72, 110592
    s_add_u32 s77, s72, s3
    buffer_load_dwordx4 v220, s[24:27], s77 offen offset:0  lds
    buffer_load_dwordx4 v221, s[24:27], s77 offen offset:1024  lds
    buffer_load_dwordx4 v222, s[24:27], s77 offen offset:2048  lds
    buffer_load_dwordx4 v223, s[24:27], s77 offen offset:3072  lds
    s_add_u32 m0, s78, 12288
    s_add_u32 s72, s74, 3
    s_cmp_ge_u32 s72, 16
    s_cselect_b32 s77, 16, 0
    s_sub_u32 s72, s72, s77
    s_mul_i32 s72, s72, 110592
    s_add_u32 s77, s72, s3
    buffer_load_dwordx4 v220, s[24:27], s77 offen offset:0  lds
    buffer_load_dwordx4 v221, s[24:27], s77 offen offset:1024  lds
    buffer_load_dwordx4 v222, s[24:27], s77 offen offset:2048  lds
    buffer_load_dwordx4 v223, s[24:27], s77 offen offset:3072  lds
    s_add_u32 m0, s78, 16384
    s_add_u32 s72, s74, 4
    s_cmp_ge_u32 s72, 16
    s_cselect_b32 s77, 16, 0
    s_sub_u32 s72, s72, s77
    s_mul_i32 s72, s72, 110592
    s_add_u32 s77, s72, s3
    buffer_load_dwordx4 v220, s[24:27], s77 offen offset:0  lds
    buffer_load_dwordx4 v221, s[24:27], s77 offen offset:1024  lds
    buffer_load_dwordx4 v222, s[24:27], s77 offen offset:2048  lds
    buffer_load_dwordx4 v223, s[24:27], s77 offen offset:3072  lds
    s_waitcnt vmcnt(12)
    s_branch L_ln_go2
L_ln_idle2:
    s_waitcnt vmcnt(0)
L_ln_go2:
    v_readfirstlane_b32 s67, v214
    s_cmp_lg_u32 s67, 0
    s_cbranch_scc1 L_nonced_2
    s_mov_b32 s79, 0
    v_mov_b32 v15, 0
L_nonce_1:
    buffer_load_dword v9, v15, s[56:59], 0 offen sc1
    s_waitcnt vmcnt(0)
    v_readfirstlane_b32 s67, v9
    s_add_u32 s79, s79, 1
    s_cmp_lg_u32 s67, 0
    s_cbranch_scc1 L_nonced_2
    s_cmp_lt_u32 s79, 20000
    s_cbranch_scc1 L_nonce_1
L_nonced_2:
    s_barrier
    s_cmp_lg_u32 s60, 0
    s_cbranch_scc1 L_noflag
    s_lshr_b32 s68, s2, 2
    s_mul_i32 s68, s68, 16
    s_and_b32 s69, s2, 3
    s_lshl_b32 s69, s69, 2
    s_add_u32 s68, s68, s69
    v_mov_b32 v15, s68
    v_mov_b32 v9, s67
    s_mov_b64 s[80:81], exec
    s_mov_b64 exec, 1
    buffer_store_dword v9, v15, s[44:47], 0 offen sc1
    s_mov_b64 exec, s[80:81]
L_noflag:
    s_cmp_ge_u32 s62, s100
    s_cbranch_scc1 L_nogemm1
    s_waitcnt vmcnt(13)
    ds_read_b64_tr_b16 a[0:1], v2 offset:0
    ds_read_b64_tr_b16 a[2:3], v2 offset:2048
    ds_read_b64_tr_b16 a[4:5], v3 offset:0
    ds_read_b64_tr_b16 a[6:7], v3 offset:2048
    ds_read_b64_tr_b16 a[8:9], v4 offset:0
    ds_read_b64_tr_b16 a[10:11], v4 offset:2048
    ds_read_b64_tr_b16 a[12:13], v5 offset:0
    ds_read_b64_tr_b16 a[14:15], v5 offset:2048
    s_waitcnt vmcnt(12)
    s_waitcnt lgkmcnt(0)
    ds_read_b64_tr_b16 a[16:17], v2 offset:4096
    ds_read_b64_tr_b16 a[18:19], v2 offset:6144
    ds_read_b64_tr_b16 a[20:21], v3 offset:4096
    ds_read_b64_tr_b16 a[22:23], v3 offset:6144
    ds_read_b64_tr_b16 a[24:25], v4 offset:4096
    ds_read_b64_tr_b16 a[26:27], v4 offset:6144
    ds_read_b64_tr_b16 a[28:29], v5 offset:4096
    ds_read_b64_tr_b16 a[30:31], v5 offset:6144
    s_add_u32 m0, s78, 20480
    s_add_u32 s72, s74, 5
    s_cmp_ge_u32 s72, 16
    s_cselect_b32 s77, 16, 0
    s_sub_u32 s72, s72, s77
    s_mul_i32 s72, s72, 110592
    s_add_u32 s77, s72, s3
    buffer_load_dwordx4 v220, s[24:27], s77 offen offset:0  lds
    buffer_load_dwordx4 v221, s[24:27], s77 offen offset:1024  lds
    buffer_load_dwordx4 v222, s[24:27], s77 offen offset:2048  lds
    buffer_load_dwordx4 v223, s[24:27], s77 offen offset:3072  lds
    s_waitcnt vmcnt(12)
    s_waitcnt lgkmcnt(0)
    ds_read_b64_tr_b16 a[32:33], v2 offset:8192
    ds_read_b64_tr_b16 a[34:35], v2 offset:10240
    ds_read_b64_tr_b16 a[36:37], v3 offset:8192
    ds_read_b64_tr_b16 a[38:39], v3 offset:10240
    ds_read_b64_tr_b16 a[40:41], v4 offset:8192
    ds_read_b64_tr_b16 a[42:43], v4 offset:10240
    ds_read_b64_tr_b16 a[44:45], v5 offset:8192
    ds_read_b64_tr_b16 a[46:47], v5 offset:10240
    s_add_u32 m0, s78, 24576
    s_add_u32 s72, s74, 6
    s_cmp_ge_u32 s72, 16
    s_cselect_b32 s77, 16, 0
    s_sub_u32 s72, s72, s77
    s_mul_i32 s72, s72, 110592
    s_add_u32 s77, s72, s3
    buffer_load_dwordx4 v220, s[24:27], s77 offen offset:0  lds
    buffer_load_dwordx4 v221, s[24:27], s77 offen offset:1024  lds
    buffer_load_dwordx4 v222, s[24:27], s77 offen offset:2048  lds
    buffer_load_dwordx4 v223, s[24:27], s77 offen offset:3072  lds
    s_waitcnt vmcnt(12)
    s_waitcnt lgkmcnt(0)
    ds_read_b64_tr_b16 a[48:49], v2 offset:12288
    ds_read_b64_tr_b16 a[50:51], v2 offset:14336
    ds_read_b64_tr_b16 a[52:53], v3 offset:12288
    ds_read_b64_tr_b16 a[54:55], v3 offset:14336
    ds_read_b64_tr_b16 a[56:57], v4 offset:12288
    ds_read_b64_tr_b16 a[58:59], v4 offset:14336
    ds_read_b64_tr_b16 a[60:61], v5 offset:12288
    ds_read_b64_tr_b16 a[62:63], v5 offset:14336
    s_add_u32 m0, s78, 28672
    s_add_u32 s72, s74, 7
    s_cmp_ge_u32 s72, 16
    s_cselect_b32 s77, 16, 0
    s_sub_u32 s72, s72, s77
    s_mul_i32 s72, s72, 110592
    s_add_u32 s77, s72, s3
    buffer_load_dwordx4 v220, s[24:27], s77 offen offset:0  lds
    buffer_load_dwordx4 v221, s[24:27], s77 offen offset:1024  lds
    buffer_load_dwordx4 v222, s[24:27], s77 offen offset:2048  lds
    buffer_load_dwordx4 v223, s[24:27], s77 offen offset:3072  lds
    s_waitcnt vmcnt(12)
    s_waitcnt lgkmcnt(0)
    ds_read_b64_tr_b16 a[64:65], v2 offset:16384
    ds_read_b64_tr_b16 a[66:67], v2 offset:18432
    ds_read_b64_tr_b16 a[68:69], v3 offset:16384
    ds_read_b64_tr_b16 a[70:71], v3 offset:18432
    ds_read_b64_tr_b16 a[72:73], v4 offset:16384
    ds_read_b64_tr_b16 a[74:75], v4 offset:18432
    ds_read_b64_tr_b16 a[76:77], v5 offset:16384
    ds_read_b64_tr_b16 a[78:79], v5 offset:18432
    s_add_u32 m0, s78, 0
    s_add_u32 s72, s74, 8
    s_cmp_ge_u32 s72, 16
    s_cselect_b32 s77, 16, 0
    s_sub_u32 s72, s72, s77
    s_mul_i32 s72, s72, 110592
    s_add_u32 s77, s72, s3
    buffer_load_dwordx4 v220, s[24:27], s77 offen offset:0  lds
    buffer_load_dwordx4 v221, s[24:27], s77 offen offset:1024  lds
    buffer_load_dwordx4 v222, s[24:27], s77 offen offset:2048  lds
    buffer_load_dwordx4 v223, s[24:27], s77 offen offset:3072  lds
    s_waitcnt vmcnt(12)
    s_waitcnt lgkmcnt(0)
    ds_read_b64_tr_b16 a[80:81], v2 offset:20480
    ds_read_b64_tr_b16 a[82:83], v2 offset:22528
    ds_read_b64_tr_b16 a[84:85], v3 offset:20480
    ds_read_b64_tr_b16 a[86:87], v3 offset:22528
    ds_read_b64_tr_b16 a[88:89], v4 offset:20480
    ds_read_b64_tr_b16 a[90:91], v4 offset:22528
    ds_read_b64_tr_b16 a[92:93], v5 offset:20480
    ds_read_b64_tr_b16 a[94:95], v5 offset:22528
    s_add_u32 m0, s78, 4096
    s_add_u32 s72, s74, 9
    s_cmp_ge_u32 s72, 16
    s_cselect_b32 s77, 16, 0
    s_sub_u32 s72, s72, s77
    s_mul_i32 s72, s72, 110592
    s_add_u32 s77, s72, s3
    buffer_load_dwordx4 v220, s[24:27], s77 offen offset:0  lds
    buffer_load_dwordx4 v221, s[24:27], s77 offen offset:1024  lds
    buffer_load_dwordx4 v222, s[24:27], s77 offen offset:2048  lds
    buffer_load_dwordx4 v223, s[24:27], s77 offen offset:3072  lds
    s_waitcnt vmcnt(12)
    s_waitcnt lgkmcnt(0)
    ds_read_b64_tr_b16 a[96:97], v2 offset:24576
    ds_read_b64_tr_b16 a[98:99], v2 offset:26624
    ds_read_b64_tr_b16 a[100:101], v3 offset:24576
    ds_read_b64_tr_b16 a[102:103], v3 offset:26624
    ds_read_b64_tr_b16 a[104:105], v4 offset:24576
    ds_read_b64_tr_b16 a[106:107], v4 offset:26624
    ds_read_b64_tr_b16 a[108:109], v5 offset:24576
    ds_read_b64_tr_b16 a[110:111], v5 offset:26624
    s_add_u32 m0, s78, 8192
    s_add_u32 s72, s74, 10
    s_cmp_ge_u32 s72, 16
    s_cselect_b32 s77, 16, 0
    s_sub_u32 s72, s72, s77
    s_mul_i32 s72, s72, 110592
    s_add_u32 s77, s72, s3
    buffer_load_dwordx4 v220, s[24:27], s77 offen offset:0  lds
    buffer_load_dwordx4 v221, s[24:27], s77 offen offset:1024  lds
    buffer_load_dwordx4 v222, s[24:27], s77 offen offset:2048  lds
    buffer_load_dwordx4 v223, s[24:27], s77 offen offset:3072  lds
    s_waitcnt vmcnt(12)
    s_waitcnt lgkmcnt(0)
    ds_read_b64_tr_b16 a[112:113], v2 offset:28672
    ds_read_b64_tr_b16 a[114:115], v2 offset:30720
    ds_read_b64_tr_b16 a[116:117], v3 offset:28672
    ds_read_b64_tr_b16 a[118:119], v3 offset:30720
    ds_read_b64_tr_b16 a[120:121], v4 offset:28672
    ds_read_b64_tr_b16 a[122:123], v4 offset:30720
    ds_read_b64_tr_b16 a[124:125], v5 offset:28672
    ds_read_b64_tr_b16 a[126:127], v5 offset:30720
    s_add_u32 m0, s78, 12288
    s_add_u32 s72, s74, 11
    s_cmp_ge_u32 s72, 16
    s_cselect_b32 s77, 16, 0
    s_sub_u32 s72, s72, s77
    s_mul_i32 s72, s72, 110592
    s_add_u32 s77, s72, s3
    buffer_load_dwordx4 v220, s[24:27], s77 offen offset:0  lds
    buffer_load_dwordx4 v221, s[24:27], s77 offen offset:1024  lds
    buffer_load_dwordx4 v222, s[24:27], s77 offen offset:2048  lds
    buffer_load_dwordx4 v223, s[24:27], s77 offen offset:3072  lds
    s_waitcnt vmcnt(12)
    s_waitcnt lgkmcnt(0)
    ds_read_b64_tr_b16 a[128:129], v2 offset:0
    ds_read_b64_tr_b16 a[130:131], v2 offset:2048
    ds_read_b64_tr_b16 a[132:133], v3 offset:0
    ds_read_b64_tr_b16 a[134:135], v3 offset:2048
    ds_read_b64_tr_b16 a[136:137], v4 offset:0
    ds_read_b64_tr_b16 a[138:139], v4 offset:2048
    ds_read_b64_tr_b16 a[140:141], v5 offset:0
    ds_read_b64_tr_b16 a[142:143], v5 offset:2048
    s_add_u32 m0, s78, 16384
    s_add_u32 s72, s74, 12
    s_cmp_ge_u32 s72, 16
    s_cselect_b32 s77, 16, 0
    s_sub_u32 s72, s72, s77
    s_mul_i32 s72, s72, 110592
    s_add_u32 s77, s72, s3
    buffer_load_dwordx4 v220, s[24:27], s77 offen offset:0  lds
    buffer_load_dwordx4 v221, s[24:27], s77 offen offset:1024  lds
    buffer_load_dwordx4 v222, s[24:27], s77 offen offset:2048  lds
    buffer_load_dwordx4 v223, s[24:27], s77 offen offset:3072  lds
    v_mul_u32_u24 v226, 16, v1
    s_cmp_lg_u32 s60, 3
    s_cbranch_scc1 L_noepoll
    buffer_load_dwordx4 v[228:231], v226, s[44:47], 0 offen sc1
L_noepoll:
    s_waitcnt vmcnt(12)
    s_waitcnt lgkmcnt(0)
    ds_read_b64_tr_b16 a[144:145], v2 offset:4096
    ds_read_b64_tr_b16 a[146:147], v2 offset:6144
    ds_read_b64_tr_b16 a[148:149], v3 offset:4096
    ds_read_b64_tr_b16 a[150:151], v3 offset:6144
    ds_read_b64_tr_b16 a[152:153], v4 offset:4096
    ds_read_b64_tr_b16 a[154:155], v4 offset:6144
    ds_read_b64_tr_b16 a[156:157], v5 offset:4096
    ds_read_b64_tr_b16 a[158:159], v5 offset:6144
    s_add_u32 m0, s78, 20480
    s_add_u32 s72, s74, 13
    s_cmp_ge_u32 s72, 16
    s_cselect_b32 s77, 16, 0
    s_sub_u32 s72, s72, s77
    s_mul_i32 s72, s72, 110592
    s_add_u32 s77, s72, s3
    buffer_load_dwordx4 v220, s[24:27], s77 offen offset:0  lds
    buffer_load_dwordx4 v221, s[24:27], s77 offen offset:1024  lds
    buffer_load_dwordx4 v222, s[24:27], s77 offen offset:2048  lds
    buffer_load_dwordx4 v223, s[24:27], s77 offen offset:3072  lds
    s_waitcnt vmcnt(12)
    s_waitcnt lgkmcnt(0)
    ds_read_b64_tr_b16 a[160:161], v2 offset:8192
    ds_read_b64_tr_b16 a[162:163], v2 offset:10240
    ds_read_b64_tr_b16 a[164:165], v3 offset:8192
    ds_read_b64_tr_b16 a[166:167], v3 offset:10240
    ds_read_b64_tr_b16 a[168:169], v4 offset:8192
    ds_read_b64_tr_b16 a[170:171], v4 offset:10240
    ds_read_b64_tr_b16 a[172:173], v5 offset:8192
    ds_read_b64_tr_b16 a[174:175], v5 offset:10240
    s_add_u32 m0, s78, 24576
    s_add_u32 s72, s74, 14
    s_cmp_ge_u32 s72, 16
    s_cselect_b32 s77, 16, 0
    s_sub_u32 s72, s72, s77
    s_mul_i32 s72, s72, 110592
    s_add_u32 s77, s72, s3
    buffer_load_dwordx4 v220, s[24:27], s77 offen offset:0  lds
    buffer_load_dwordx4 v221, s[24:27], s77 offen offset:1024  lds
    buffer_load_dwordx4 v222, s[24:27], s77 offen offset:2048  lds
    buffer_load_dwordx4 v223, s[24:27], s77 offen offset:3072  lds
    s_waitcnt vmcnt(12)
    s_waitcnt lgkmcnt(0)
    ds_read_b64_tr_b16 a[176:177], v2 offset:12288
    ds_read_b64_tr_b16 a[178:179], v2 offset:14336
    ds_read_b64_tr_b16 a[180:181], v3 offset:12288
    ds_read_b64_tr_b16 a[182:183], v3 offset:14336
    ds_read_b64_tr_b16 a[184:185], v4 offset:12288
    ds_read_b64_tr_b16 a[186:187], v4 offset:14336
    ds_read_b64_tr_b16 a[188:189], v5 offset:12288
    ds_read_b64_tr_b16 a[190:191], v5 offset:14336
    s_add_u32 m0, s78, 28672
    s_add_u32 s72, s74, 15
    s_cmp_ge_u32 s72, 16
    s_cselect_b32 s77, 16, 0
    s_sub_u32 s72, s72, s77
    s_mul_i32 s72, s72, 110592
    s_add_u32 s77, s72, s3
    buffer_load_dwordx4 v220, s[24:27], s77 offen offset:0  lds
    buffer_load_dwordx4 v221, s[24:27], s77 offen offset:1024  lds
    buffer_load_dwordx4 v222, s[24:27], s77 offen offset:2048  lds
    buffer_load_dwordx4 v223, s[24:27], s77 offen offset:3072  lds
L_w1_ready:
    s_mov_b32 s32, s18
    s_and_b32 s33, s19, 0xffff
    s_mov_b32 s34, 2621440
    s_mov_b32 s35, 0x20000
    s_add_u32 s44, s18, 6291456
    s_addc_u32 s45, s19, 0
    s_and_b32 s45, s45, 0xffff
    s_mov_b32 s46, 262144
    s_mov_b32 s47, 0x20000
    s_mov_b32 s48, s8
    s_and_b32 s49, s9, 0xffff
    s_mov_b32 s50, 3456
    s_mov_b32 s51, 0x20000
    s_mov_b32 s28, s10
    s_and_b32 s29, s11, 0xffff
    s_mov_b32 s30, 7077888
    s_mov_b32 s31, 0x20000
    s_mov_b32 s52, s12
    s_and_b32 s53, s13, 0xffff
    s_mov_b32 s54, 4096
    s_mov_b32 s55, 0x20000
    s_mov_b32 s40, s14
    s_and_b32 s41, s15, 0xffff
    s_mov_b32 s42, 2621440
    s_mov_b32 s43, 0x20000
    s_add_u32 s36, s18, 3145728
    s_addc_u32 s37, s19, 0
    s_and_b32 s37, s37, 0xffff
    s_mov_b32 s38, 2211840
    s_mov_b32 s39, 0x20000
    v_lshrrev_b32 v15, 4, v1
    v_lshlrev_b32 v15, 3, v15
    s_and_b32 s68, s60, 1
    s_lshl_b32 s68, s68, 6
    s_lshl_b32 s69, s63, 7
    s_add_u32 s68, s68, s69
    buffer_load_dwordx2 v[10:11], v15, s[48:51], s68 offen
    buffer_load_dwordx2 v[12:13], v15, s[48:51], s68 offen offset:32
    v_and_b32 v15, 15, v1
    v_lshlrev_b32 v15, 1, v15
    s_lshl_b32 s68, s65, 7
    s_lshl_b32 s69, s60, 5
    s_add_u32 s68, s68, s69
    buffer_load_ushort v14, v15, s[52:55], s68 offen
    v_lshrrev_b32 v15, 3, v1
    v_lshrrev_b32 v9, 1, v15
    v_lshlrev_b32 v9, 1, v9
    v_and_b32 v220, 7, v1
    v_xor_b32 v220, v220, v9
    v_lshlrev_b32 v220, 4, v220
    v_mul_u32_u24 v15, 4096, v15
    v_add_u32 v220, v220, v15
    s_lshl_b32 s68, s65, 7
    v_add_u32 v220, s68, v220
    v_add_u32 v221, 31744, v220
    v_add_u32 v222, 63488, v220
    v_add_u32 v223, 95232, v220
    s_mul_i32 s3, s60, 1835008
    s_sub_u32 s68, s99, s78
    v_add_u32 v196, s68, v2
    v_add_u32 v197, s68, v3
    v_add_u32 v198, s68, v4
    v_add_u32 v199, s68, v5
    v_lshlrev_b32 v200, 4, v1
    v_add_u32 v201, 65536, v200
    v_add_u32 v202, 131072, v200
    s_mul_i32 s68, s64, 5120
    v_add_u32 v6, s68, v200
    v_add_u32 v7, 4096, v6
    s_cmp_lg_u32 s60, 3
    s_cbranch_scc1 L_hpolled
    s_waitcnt vmcnt(15)
    v_cmp_ne_u32 vcc, s67, v228
    v_cmp_ne_u32 s[80:81], s67, v229
    s_or_b64 vcc, vcc, s[80:81]
    v_cmp_ne_u32 s[80:81], s67, v230
    s_or_b64 vcc, vcc, s[80:81]
    v_cmp_ne_u32 s[80:81], s67, v231
    s_or_b64 vcc, vcc, s[80:81]
    s_cmp_eq_u64 vcc, 0
    s_cbranch_scc1 L_hpolled
    s_mov_b32 s79, 0
L_poll_3:
    buffer_load_dwordx4 v[228:231], v226, s[44:47], 0 offen offset:0 sc1
    s_waitcnt vmcnt(0)
    v_cmp_ne_u32 vcc, s67, v228
    v_cmp_ne_u32 s[80:81], s67, v229
    s_or_b64 vcc, vcc, s[80:81]
    v_cmp_ne_u32 s[80:81], s67, v230
    s_or_b64 vcc, vcc, s[80:81]
    v_cmp_ne_u32 s[80:81], s67, v231
    s_or_b64 vcc, vcc, s[80:81]
    s_add_u32 s79, s79, 1
    s_cmp_eq_u64 vcc, 0
    s_cbranch_scc1 L_polled_4
    s_sleep 4
    s_cmp_lt_u32 s79, 20000
    s_cbranch_scc1 L_poll_3
L_polled_4:
L_hpolled:
    s_barrier
    s_mul_i32 s76, s60, 655360
    s_add_u32 s72, s74, 0
    s_cmp_ge_u32 s72, 16
    s_cselect_b32 s77, 16, 0
    s_sub_u32 s72, s72, s77
    s_mul_i32 s72, s72, 40960
    s_add_u32 s77, s72, s76
    buffer_load_dwordx4 v[96:99], v6, s[32:35], s77 offen offset:0 sc1
    buffer_load_dwordx4 v[100:103], v6, s[32:35], s77 offen offset:1024 sc1
    buffer_load_dwordx4 v[104:107], v6, s[32:35], s77 offen offset:2048 sc1
    buffer_load_dwordx4 v[108:111], v6, s[32:35], s77 offen offset:3072 sc1
    buffer_load_dwordx4 v[112:115], v7, s[32:35], s77 offen offset:0 sc1
    s_add_u32 s72, s74, 1
    s_cmp_ge_u32 s72, 16
    s_cselect_b32 s77, 16, 0
    s_sub_u32 s72, s72, s77
    s_mul_i32 s72, s72, 40960
    s_add_u32 s77, s72, s76
    buffer_load_dwordx4 v[116:119], v6, s[32:35], s77 offen offset:0 sc1
    buffer_load_dwordx4 v[120:123], v6, s[32:35], s77 offen offset:1024 sc1
    buffer_load_dwordx4 v[124:127], v6, s[32:35], s77 offen offset:2048 sc1
    buffer_load_dwordx4 v[128:131], v6, s[32:35], s77 offen offset:3072 sc1
    buffer_load_dwordx4 v[132:135], v7, s[32:35], s77 offen offset:0 sc1
    s_add_u32 s72, s74, 2
    s_cmp_ge_u32 s72, 16
    s_cselect_b32 s77, 16, 0
    s_sub_u32 s72, s72, s77
    s_mul_i32 s72, s72, 40960
    s_add_u32 s77, s72, s76
    buffer_load_dwordx4 v[136:139], v6, s[32:35], s77 offen offset:0 sc1
    buffer_load_dwordx4 v[140:143], v6, s[32:35], s77 offen offset:1024 sc1
    s_waitcnt vmcnt(27)
    s_waitcnt lgkmcnt(0)
    ds_read_b64_tr_b16 a[192:193], v2 offset:16384
    ds_read_b64_tr_b16 a[194:195], v2 offset:18432
    ds_read_b64_tr_b16 a[196:197], v3 offset:16384
    ds_read_b64_tr_b16 a[198:199], v3 offset:18432
    ds_read_b64_tr_b16 a[200:201], v4 offset:16384
    ds_read_b64_tr_b16 a[202:203], v4 offset:18432
    ds_read_b64_tr_b16 a[204:205], v5 offset:16384
    ds_read_b64_tr_b16 a[206:207], v5 offset:18432
    s_waitcnt vmcnt(23)
    s_waitcnt lgkmcnt(0)
    ds_read_b64_tr_b16 a[208:209], v2 offset:20480
    ds_read_b64_tr_b16 a[210:211], v2 offset:22528
    ds_read_b64_tr_b16 a[212:213], v3 offset:20480
    ds_read_b64_tr_b16 a[214:215], v3 offset:22528
    ds_read_b64_tr_b16 a[216:217], v4 offset:20480
    ds_read_b64_tr_b16 a[218:219], v4 offset:22528
    ds_read_b64_tr_b16 a[220:221], v5 offset:20480
    ds_read_b64_tr_b16 a[222:223], v5 offset:22528
    s_waitcnt vmcnt(19)
    s_waitcnt lgkmcnt(0)
    ds_read_b64_tr_b16 a[224:225], v2 offset:24576
    ds_read_b64_tr_b16 a[226:227], v2 offset:26624
    ds_read_b64_tr_b16 a[228:229], v3 offset:24576
    ds_read_b64_tr_b16 a[230:231], v3 offset:26624
    ds_read_b64_tr_b16 a[232:233], v4 offset:24576
    ds_read_b64_tr_b16 a[234:235], v4 offset:26624
    ds_read_b64_tr_b16 a[236:237], v5 offset:24576
    ds_read_b64_tr_b16 a[238:239], v5 offset:26624
    s_waitcnt vmcnt(15)
    s_waitcnt lgkmcnt(0)
    ds_read_b64_tr_b16 a[240:241], v2 offset:28672
    ds_read_b64_tr_b16 a[242:243], v2 offset:30720
    ds_read_b64_tr_b16 a[244:245], v3 offset:28672
    ds_read_b64_tr_b16 a[246:247], v3 offset:30720
    ds_read_b64_tr_b16 a[248:249], v4 offset:28672
    ds_read_b64_tr_b16 a[250:251], v4 offset:30720
    ds_read_b64_tr_b16 a[252:253], v5 offset:28672
    ds_read_b64_tr_b16 a[254:255], v5 offset:30720
    s_waitcnt lgkmcnt(0)
    s_waitcnt vmcnt(11)
    buffer_load_dwordx4 v[144:147], v6, s[32:35], s77 offen offset:2048 sc1
    v_mfma_f32_16x16x32_bf16 v[16:19], a[0:3], v[96:99], 0
    v_mfma_f32_16x16x32_bf16 v[36:39], a[4:7], v[96:99], 0
    v_mfma_f32_16x16x32_bf16 v[56:59], a[8:11], v[96:99], 0
    v_mfma_f32_16x16x32_bf16 v[76:79], a[12:15], v[96:99], 0
    s_waitcnt vmcnt(11)
    buffer_load_dwordx4 v[148:151], v6, s[32:35], s77 offen offset:3072 sc1
    v_mfma_f32_16x16x32_bf16 v[20:23], a[0:3], v[100:103], 0
    v_mfma_f32_16x16x32_bf16 v[40:43], a[4:7], v[100:103], 0
    v_mfma_f32_16x16x32_bf16 v[60:63], a[8:11], v[100:103], 0
    v_mfma_f32_16x16x32_bf16 v[80:83], a[12:15], v[100:103], 0
    s_waitcnt vmcnt(11)
    buffer_load_dwordx4 v[152:155], v7, s[32:35], s77 offen offset:0 sc1
    v_mfma_f32_16x16x32_bf16 v[24:27], a[0:3], v[104:107], 0
    v_mfma_f32_16x16x32_bf16 v[44:47], a[4:7], v[104:107], 0
    v_mfma_f32_16x16x32_bf16 v[64:67], a[8:11], v[104:107], 0
    v_mfma_f32_16x16x32_bf16 v[84:87], a[12:15], v[104:107], 0
    s_waitcnt vmcnt(11)
    s_add_u32 s72, s74, 3
    s_cmp_ge_u32 s72, 16
    s_cselect_b32 s77, 16, 0
    s_sub_u32 s72, s72, s77
    s_mul_i32 s72, s72, 40960
    s_add_u32 s77, s72, s76
    buffer_load_dwordx4 v[96:99], v6, s[32:35], s77 offen offset:0 sc1
    v_mfma_f32_16x16x32_bf16 v[28:31], a[0:3], v[108:111], 0
    v_mfma_f32_16x16x32_bf16 v[48:51], a[4:7], v[108:111], 0
    v_mfma_f32_16x16x32_bf16 v[68:71], a[8:11], v[108:111], 0
    v_mfma_f32_16x16x32_bf16 v[88:91], a[12:15], v[108:111], 0
    s_waitcnt vmcnt(11)
    buffer_load_dwordx4 v[100:103], v6, s[32:35], s77 offen offset:1024 sc1
    v_mfma_f32_16x16x32_bf16 v[32:35], a[0:3], v[112:115], 0
    v_mfma_f32_16x16x32_bf16 v[52:55], a[4:7], v[112:115], 0
    v_mfma_f32_16x16x32_bf16 v[72:75], a[8:11], v[112:115], 0
    v_mfma_f32_16x16x32_bf16 v[92:95], a[12:15], v[112:115], 0
    s_waitcnt vmcnt(11)
    buffer_load_dwordx4 v[104:107], v6, s[32:35], s77 offen offset:2048 sc1
    v_mfma_f32_16x16x32_bf16 v[16:19], a[16:19], v[116:119], v[16:19]
    v_mfma_f32_16x16x32_bf16 v[36:39], a[20:23], v[116:119], v[36:39]
    v_mfma_f32_16x16x32_bf16 v[56:59], a[24:27], v[116:119], v[56:59]
    v_mfma_f32_16x16x32_bf16 v[76:79], a[28:31], v[116:119], v[76:79]
    s_waitcnt vmcnt(11)
    buffer_load_dwordx4 v[108:111], v6, s[32:35], s77 offen offset:3072 sc1
    v_mfma_f32_16x16x32_bf16 v[20:23], a[16:19], v[120:123], v[20:23]
    v_mfma_f32_16x16x32_bf16 v[40:43], a[20:23], v[120:123], v[40:43]
    v_mfma_f32_16x16x32_bf16 v[60:63], a[24:27], v[120:123], v[60:63]
    v_mfma_f32_16x16x32_bf16 v[80:83], a[28:31], v[120:123], v[80:83]
    s_waitcnt vmcnt(11)
    buffer_load_dwordx4 v[112:115], v7, s[32:35], s77 offen offset:0 sc1
    v_mfma_f32_16x16x32_bf16 v[24:27], a[16:19], v[124:127], v[24:27]
    v_mfma_f32_16x16x32_bf16 v[44:47], a[20:23], v[124:127], v[44:47]
    v_mfma_f32_16x16x32_bf16 v[64:67], a[24:27], v[124:127], v[64:67]
    v_mfma_f32_16x16x32_bf16 v[84:87], a[28:31], v[124:127], v[84:87]
    s_waitcnt vmcnt(11)
    s_add_u32 s72, s74, 4
    s_cmp_ge_u32 s72, 16
    s_cselect_b32 s77, 16, 0
    s_sub_u32 s72, s72, s77
    s_mul_i32 s72, s72, 40960
    s_add_u32 s77, s72, s76
    buffer_load_dwordx4 v[116:119], v6, s[32:35], s77 offen offset:0 sc1
    v_mfma_f32_16x16x32_bf16 v[28:31], a[16:19], v[128:131], v[28:31]
    v_mfma_f32_16x16x32_bf16 v[48:51], a[20:23], v[128:131], v[48:51]
    v_mfma_f32_16x16x32_bf16 v[68:71], a[24:27], v[128:131], v[68:71]
    v_mfma_f32_16x16x32_bf16 v[88:91], a[28:31], v[128:131], v[88:91]
    s_waitcnt vmcnt(11)
    buffer_load_dwordx4 v[120:123], v6, s[32:35], s77 offen offset:1024 sc1
    v_mfma_f32_16x16x32_bf16 v[32:35], a[16:19], v[132:135], v[32:35]
    v_mfma_f32_16x16x32_bf16 v[52:55], a[20:23], v[132:135], v[52:55]
    v_mfma_f32_16x16x32_bf16 v[72:75], a[24:27], v[132:135], v[72:75]
    v_mfma_f32_16x16x32_bf16 v[92:95], a[28:31], v[132:135], v[92:95]
    s_waitcnt vmcnt(11)
    buffer_load_dwordx4 v[124:127], v6, s[32:35], s77 offen offset:2048 sc1
    v_mfma_f32_16x16x32_bf16 v[16:19], a[32:35], v[136:139], v[16:19]
    v_mfma_f32_16x16x32_bf16 v[36:39], a[36:39], v[136:139], v[36:39]
    v_mfma_f32_16x16x32_bf16 v[56:59], a[40:43], v[136:139], v[56:59]
    v_mfma_f32_16x16x32_bf16 v[76:79], a[44:47], v[136:139], v[76:79]
    s_waitcnt vmcnt(11)
    buffer_load_dwordx4 v[128:131], v6, s[32:35], s77 offen offset:3072 sc1
    v_mfma_f32_16x16x32_bf16 v[20:23], a[32:35], v[140:143], v[20:23]
    v_mfma_f32_16x16x32_bf16 v[40:43], a[36:39], v[140:143], v[40:43]
    v_mfma_f32_16x16x32_bf16 v[60:63], a[40:43], v[140:143], v[60:63]
    v_mfma_f32_16x16x32_bf16 v[80:83], a[44:47], v[140:143], v[80:83]
    s_waitcnt vmcnt(11)
    buffer_load_dwordx4 v[132:135], v7, s[32:35], s77 offen offset:0 sc1
    v_mfma_f32_16x16x32_bf16 v[24:27], a[32:35], v[144:147], v[24:27]
    v_mfma_f32_16x16x32_bf16 v[44:47], a[36:39], v[144:147], v[44:47]
    v_mfma_f32_16x16x32_bf16 v[64:67], a[40:43], v[144:147], v[64:67]
    v_mfma_f32_16x16x32_bf16 v[84:87], a[44:47], v[144:147], v[84:87]
    s_waitcnt vmcnt(11)
    s_add_u32 s72, s74, 5
    s_cmp_ge_u32 s72, 16
    s_cselect_b32 s77, 16, 0
    s_sub_u32 s72, s72, s77
    s_mul_i32 s72, s72, 40960
    s_add_u32 s77, s72, s76
    buffer_load_dwordx4 v[136:139], v6, s[32:35], s77 offen offset:0 sc1
    v_mfma_f32_16x16x32_bf16 v[28:31], a[32:35], v[148:151], v[28:31]
    v_mfma_f32_16x16x32_bf16 v[48:51], a[36:39], v[148:151], v[48:51]
    v_mfma_f32_16x16x32_bf16 v[68:71], a[40:43], v[148:151], v[68:71]
    v_mfma_f32_16x16x32_bf16 v[88:91], a[44:47], v[148:151], v[88:91]
    s_waitcnt vmcnt(11)
    buffer_load_dwordx4 v[140:143], v6, s[32:35], s77 offen offset:1024 sc1
    v_mfma_f32_16x16x32_bf16 v[32:35], a[32:35], v[152:155], v[32:35]
    v_mfma_f32_16x16x32_bf16 v[52:55], a[36:39], v[152:155], v[52:55]
    v_mfma_f32_16x16x32_bf16 v[72:75], a[40:43], v[152:155], v[72:75]
    v_mfma_f32_16x16x32_bf16 v[92:95], a[44:47], v[152:155], v[92:95]
    s_waitcnt vmcnt(11)
    buffer_load_dwordx4 v[144:147], v6, s[32:35], s77 offen offset:2048 sc1
    v_mfma_f32_16x16x32_bf16 v[16:19], a[48:51], v[96:99], v[16:19]
    v_mfma_f32_16x16x32_bf16 v[36:39], a[52:55], v[96:99], v[36:39]
    v_mfma_f32_16x16x32_bf16 v[56:59], a[56:59], v[96:99], v[56:59]
    v_mfma_f32_16x16x32_bf16 v[76:79], a[60:63], v[96:99], v[76:79]
    s_waitcnt vmcnt(11)
    buffer_load_dwordx4 v[148:151], v6, s[32:35], s77 offen offset:3072 sc1
    v_mfma_f32_16x16x32_bf16 v[20:23], a[48:51], v[100:103], v[20:23]
    v_mfma_f32_16x16x32_bf16 v[40:43], a[52:55], v[100:103], v[40:43]
    v_mfma_f32_16x16x32_bf16 v[60:63], a[56:59], v[100:103], v[60:63]
    v_mfma_f32_16x16x32_bf16 v[80:83], a[60:63], v[100:103], v[80:83]
    s_waitcnt vmcnt(11)
    buffer_load_dwordx4 v[152:155], v7, s[32:35], s77 offen offset:0 sc1
    v_mfma_f32_16x16x32_bf16 v[24:27], a[48:51], v[104:107], v[24:27]
    v_mfma_f32_16x16x32_bf16 v[44:47], a[52:55], v[104:107], v[44:47]
    v_mfma_f32_16x16x32_bf16 v[64:67], a[56:59], v[104:107], v[64:67]
    v_mfma_f32_16x16x32_bf16 v[84:87], a[60:63], v[104:107], v[84:87]
    s_waitcnt vmcnt(11)
    s_add_u32 s72, s74, 6
    s_cmp_ge_u32 s72, 16
    s_cselect_b32 s77, 16, 0
    s_sub_u32 s72, s72, s77
    s_mul_i32 s72, s72, 40960
    s_add_u32 s77, s72, s76
    buffer_load_dwordx4 v[96:99], v6, s[32:35], s77 offen offset:0 sc1
    v_mfma_f32_16x16x32_bf16 v[28:31], a[48:51], v[108:111], v[28:31]
    v_mfma_f32_16x16x32_bf16 v[48:51], a[52:55], v[108:111], v[48:51]
    v_mfma_f32_16x16x32_bf16 v[68:71], a[56:59], v[108:111], v[68:71]
    v_mfma_f32_16x16x32_bf16 v[88:91], a[60:63], v[108:111], v[88:91]
    s_waitcnt vmcnt(11)
    buffer_load_dwordx4 v[100:103], v6, s[32:35], s77 offen offset:1024 sc1
    v_mfma_f32_16x16x32_bf16 v[32:35], a[48:51], v[112:115], v[32:35]
    v_mfma_f32_16x16x32_bf16 v[52:55], a[52:55], v[112:115], v[52:55]
    v_mfma_f32_16x16x32_bf16 v[72:75], a[56:59], v[112:115], v[72:75]
    v_mfma_f32_16x16x32_bf16 v[92:95], a[60:63], v[112:115], v[92:95]
    s_waitcnt vmcnt(11)
    buffer_load_dwordx4 v[104:107], v6, s[32:35], s77 offen offset:2048 sc1
    v_mfma_f32_16x16x32_bf16 v[16:19], a[64:67], v[116:119], v[16:19]
    v_mfma_f32_16x16x32_bf16 v[36:39], a[68:71], v[116:119], v[36:39]
    v_mfma_f32_16x16x32_bf16 v[56:59], a[72:75], v[116:119], v[56:59]
    v_mfma_f32_16x16x32_bf16 v[76:79], a[76:79], v[116:119], v[76:79]
    s_waitcnt vmcnt(11)
    buffer_load_dwordx4 v[108:111], v6, s[32:35], s77 offen offset:3072 sc1
    v_mfma_f32_16x16x32_bf16 v[20:23], a[64:67], v[120:123], v[20:23]
    v_mfma_f32_16x16x32_bf16 v[40:43], a[68:71], v[120:123], v[40:43]
    v_mfma_f32_16x16x32_bf16 v[60:63], a[72:75], v[120:123], v[60:63]
    v_mfma_f32_16x16x32_bf16 v[80:83], a[76:79], v[120:123], v[80:83]
    s_waitcnt vmcnt(11)
    buffer_load_dwordx4 v[112:115], v7, s[32:35], s77 offen offset:0 sc1
    v_mfma_f32_16x16x32_bf16 v[24:27], a[64:67], v[124:127], v[24:27]
    v_mfma_f32_16x16x32_bf16 v[44:47], a[68:71], v[124:127], v[44:47]
    v_mfma_f32_16x16x32_bf16 v[64:67], a[72:75], v[124:127], v[64:67]
    v_mfma_f32_16x16x32_bf16 v[84:87], a[76:79], v[124:127], v[84:87]
    s_waitcnt vmcnt(11)
    s_add_u32 s72, s74, 7
    s_cmp_ge_u32 s72, 16
    s_cselect_b32 s77, 16, 0
    s_sub_u32 s72, s72, s77
    s_mul_i32 s72, s72, 40960
    s_add_u32 s77, s72, s76
    buffer_load_dwordx4 v[116:119], v6, s[32:35], s77 offen offset:0 sc1
    v_mfma_f32_16x16x32_bf16 v[28:31], a[64:67], v[128:131], v[28:31]
    v_mfma_f32_16x16x32_bf16 v[48:51], a[68:71], v[128:131], v[48:51]
    v_mfma_f32_16x16x32_bf16 v[68:71], a[72:75], v[128:131], v[68:71]
    v_mfma_f32_16x16x32_bf16 v[88:91], a[76:79], v[128:131], v[88:91]
    s_waitcnt vmcnt(11)
    buffer_load_dwordx4 v[120:123], v6, s[32:35], s77 offen offset:1024 sc1
    v_mfma_f32_16x16x32_bf16 v[32:35], a[64:67], v[132:135], v[32:35]
    v_mfma_f32_16x16x32_bf16 v[52:55], a[68:71], v[132:135], v[52:55]
    v_mfma_f32_16x16x32_bf16 v[72:75], a[72:75], v[132:135], v[72:75]
    v_mfma_f32_16x16x32_bf16 v[92:95], a[76:79], v[132:135], v[92:95]
    s_waitcnt vmcnt(11)
    buffer_load_dwordx4 v[124:127], v6, s[32:35], s77 offen offset:2048 sc1
    v_mfma_f32_16x16x32_bf16 v[16:19], a[80:83], v[136:139], v[16:19]
    v_mfma_f32_16x16x32_bf16 v[36:39], a[84:87], v[136:139], v[36:39]
    v_mfma_f32_16x16x32_bf16 v[56:59], a[88:91], v[136:139], v[56:59]
    v_mfma_f32_16x16x32_bf16 v[76:79], a[92:95], v[136:139], v[76:79]
    s_waitcnt vmcnt(11)
    buffer_load_dwordx4 v[128:131], v6, s[32:35], s77 offen offset:3072 sc1
    v_mfma_f32_16x16x32_bf16 v[20:23], a[80:83], v[140:143], v[20:23]
    v_mfma_f32_16x16x32_bf16 v[40:43], a[84:87], v[140:143], v[40:43]
    v_mfma_f32_16x16x32_bf16 v[60:63], a[88:91], v[140:143], v[60:63]
    v_mfma_f32_16x16x32_bf16 v[80:83], a[92:95], v[140:143], v[80:83]
    s_waitcnt vmcnt(11)
    buffer_load_dwordx4 v[132:135], v7, s[32:35], s77 offen offset:0 sc1
    v_mfma_f32_16x16x32_bf16 v[24:27], a[80:83], v[144:147], v[24:27]
    v_mfma_f32_16x16x32_bf16 v[44:47], a[84:87], v[144:147], v[44:47]
    v_mfma_f32_16x16x32_bf16 v[64:67], a[88:91], v[144:147], v[64:67]
    v_mfma_f32_16x16x32_bf16 v[84:87], a[92:95], v[144:147], v[84:87]
    s_waitcnt vmcnt(11)
    s_add_u32 s72, s74, 8
    s_cmp_ge_u32 s72, 16
    s_cselect_b32 s77, 16, 0
    s_sub_u32 s72, s72, s77
    s_mul_i32 s72, s72, 40960
    s_add_u32 s77, s72, s76
    buffer_load_dwordx4 v[136:139], v6, s[32:35], s77 offen offset:0 sc1
    v_mfma_f32_16x16x32_bf16 v[28:31], a[80:83], v[148:151], v[28:31]
    v_mfma_f32_16x16x32_bf16 v[48:51], a[84:87], v[148:151], v[48:51]
    v_mfma_f32_16x16x32_bf16 v[68:71], a[88:91], v[148:151], v[68:71]
    v_mfma_f32_16x16x32_bf16 v[88:91], a[92:95], v[148:151], v[88:91]
    s_waitcnt vmcnt(11)
    buffer_load_dwordx4 v[140:143], v6, s[32:35], s77 offen offset:1024 sc1
    v_mfma_f32_16x16x32_bf16 v[32:35], a[80:83], v[152:155], v[32:35]
    v_mfma_f32_16x16x32_bf16 v[52:55], a[84:87], v[152:155], v[52:55]
    v_mfma_f32_16x16x32_bf16 v[72:75], a[88:91], v[152:155], v[72:75]
    v_mfma_f32_16x16x32_bf16 v[92:95], a[92:95], v[152:155], v[92:95]
    s_waitcnt vmcnt(11)
    buffer_load_dwordx4 v[144:147], v6, s[32:35], s77 offen offset:2048 sc1
    v_mfma_f32_16x16x32_bf16 v[16:19], a[96:99], v[96:99], v[16:19]
    v_mfma_f32_16x16x32_bf16 v[36:39], a[100:103], v[96:99], v[36:39]
    v_mfma_f32_16x16x32_bf16 v[56:59], a[104:107], v[96:99], v[56:59]
    v_mfma_f32_16x16x32_bf16 v[76:79], a[108:111], v[96:99], v[76:79]
    s_waitcnt vmcnt(11)
    buffer_load_dwordx4 v[148:151], v6, s[32:35], s77 offen offset:3072 sc1
    v_mfma_f32_16x16x32_bf16 v[20:23], a[96:99], v[100:103], v[20:23]
    v_mfma_f32_16x16x32_bf16 v[40:43], a[100:103], v[100:103], v[40:43]
    v_mfma_f32_16x16x32_bf16 v[60:63], a[104:107], v[100:103], v[60:63]
    v_mfma_f32_16x16x32_bf16 v[80:83], a[108:111], v[100:103], v[80:83]
    s_waitcnt vmcnt(11)
    buffer_load_dwordx4 v[152:155], v7, s[32:35], s77 offen offset:0 sc1
    v_mfma_f32_16x16x32_bf16 v[24:27], a[96:99], v[104:107], v[24:27]
    v_mfma_f32_16x16x32_bf16 v[44:47], a[100:103], v[104:107], v[44:47]
    v_mfma_f32_16x16x32_bf16 v[64:67], a[104:107], v[104:107], v[64:67]
    v_mfma_f32_16x16x32_bf16 v[84:87], a[108:111], v[104:107], v[84:87]
    s_waitcnt vmcnt(11)
    s_add_u32 s72, s74, 9
    s_cmp_ge_u32 s72, 16
    s_cselect_b32 s77, 16, 0
    s_sub_u32 s72, s72, s77
    s_mul_i32 s72, s72, 40960
    s_add_u32 s77, s72, s76
    buffer_load_dwordx4 v[96:99], v6, s[32:35], s77 offen offset:0 sc1
    v_mfma_f32_16x16x32_bf16 v[28:31], a[96:99], v[108:111], v[28:31]
    v_mfma_f32_16x16x32_bf16 v[48:51], a[100:103], v[108:111], v[48:51]
    v_mfma_f32_16x16x32_bf16 v[68:71], a[104:107], v[108:111], v[68:71]
    v_mfma_f32_16x16x32_bf16 v[88:91], a[108:111], v[108:111], v[88:91]
    s_waitcnt vmcnt(11)
    buffer_load_dwordx4 v[100:103], v6, s[32:35], s77 offen offset:1024 sc1
    v_mfma_f32_16x16x32_bf16 v[32:35], a[96:99], v[112:115], v[32:35]
    v_mfma_f32_16x16x32_bf16 v[52:55], a[100:103], v[112:115], v[52:55]
    v_mfma_f32_16x16x32_bf16 v[72:75], a[104:107], v[112:115], v[72:75]
    v_mfma_f32_16x16x32_bf16 v[92:95], a[108:111], v[112:115], v[92:95]
    s_waitcnt vmcnt(11)
    buffer_load_dwordx4 v[104:107], v6, s[32:35], s77 offen offset:2048 sc1
    v_mfma_f32_16x16x32_bf16 v[16:19], a[112:115], v[116:119], v[16:19]
    v_mfma_f32_16x16x32_bf16 v[36:39], a[116:119], v[116:119], v[36:39]
    v_mfma_f32_16x16x32_bf16 v[56:59], a[120:123], v[116:119], v[56:59]
    v_mfma_f32_16x16x32_bf16 v[76:79], a[124:127], v[116:119], v[76:79]
    s_waitcnt vmcnt(11)
    buffer_load_dwordx4 v[108:111], v6, s[32:35], s77 offen offset:3072 sc1
    v_mfma_f32_16x16x32_bf16 v[20:23], a[112:115], v[120:123], v[20:23]
    v_mfma_f32_16x16x32_bf16 v[40:43], a[116:119], v[120:123], v[40:43]
    v_mfma_f32_16x16x32_bf16 v[60:63], a[120:123], v[120:123], v[60:63]
    v_mfma_f32_16x16x32_bf16 v[80:83], a[124:127], v[120:123], v[80:83]
    s_waitcnt vmcnt(11)
    buffer_load_dwordx4 v[112:115], v7, s[32:35], s77 offen offset:0 sc1
    v_mfma_f32_16x16x32_bf16 v[24:27], a[112:115], v[124:127], v[24:27]
    v_mfma_f32_16x16x32_bf16 v[44:47], a[116:119], v[124:127], v[44:47]
    v_mfma_f32_16x16x32_bf16 v[64:67], a[120:123], v[124:127], v[64:67]
    v_mfma_f32_16x16x32_bf16 v[84:87], a[124:127], v[124:127], v[84:87]
    s_waitcnt vmcnt(11)
    s_add_u32 s72, s74, 10
    s_cmp_ge_u32 s72, 16
    s_cselect_b32 s77, 16, 0
    s_sub_u32 s72, s72, s77
    s_mul_i32 s72, s72, 40960
    s_add_u32 s77, s72, s76
    buffer_load_dwordx4 v[116:119], v6, s[32:35], s77 offen offset:0 sc1
    v_mfma_f32_16x16x32_bf16 v[28:31], a[112:115], v[128:131], v[28:31]
    v_mfma_f32_16x16x32_bf16 v[48:51], a[116:119], v[128:131], v[48:51]
    v_mfma_f32_16x16x32_bf16 v[68:71], a[120:123], v[128:131], v[68:71]
    v_mfma_f32_16x16x32_bf16 v[88:91], a[124:127], v[128:131], v[88:91]
    s_waitcnt vmcnt(11)
    buffer_load_dwordx4 v[120:123], v6, s[32:35], s77 offen offset:1024 sc1
    v_mfma_f32_16x16x32_bf16 v[32:35], a[112:115], v[132:135], v[32:35]
    v_mfma_f32_16x16x32_bf16 v[52:55], a[116:119], v[132:135], v[52:55]
    v_mfma_f32_16x16x32_bf16 v[72:75], a[120:123], v[132:135], v[72:75]
    v_mfma_f32_16x16x32_bf16 v[92:95], a[124:127], v[132:135], v[92:95]
    s_waitcnt vmcnt(11)
    buffer_load_dwordx4 v[124:127], v6, s[32:35], s77 offen offset:2048 sc1
    v_mfma_f32_16x16x32_bf16 v[16:19], a[128:131], v[136:139], v[16:19]
    v_mfma_f32_16x16x32_bf16 v[36:39], a[132:135], v[136:139], v[36:39]
    v_mfma_f32_16x16x32_bf16 v[56:59], a[136:139], v[136:139], v[56:59]
    v_mfma_f32_16x16x32_bf16 v[76:79], a[140:143], v[136:139], v[76:79]
    s_waitcnt vmcnt(11)
    buffer_load_dwordx4 v[128:131], v6, s[32:35], s77 offen offset:3072 sc1
    v_mfma_f32_16x16x32_bf16 v[20:23], a[128:131], v[140:143], v[20:23]
    v_mfma_f32_16x16x32_bf16 v[40:43], a[132:135], v[140:143], v[40:43]
    v_mfma_f32_16x16x32_bf16 v[60:63], a[136:139], v[140:143], v[60:63]
    v_mfma_f32_16x16x32_bf16 v[80:83], a[140:143], v[140:143], v[80:83]
    s_waitcnt vmcnt(11)
    buffer_load_dwordx4 v[132:135], v7, s[32:35], s77 offen offset:0 sc1
    v_mfma_f32_16x16x32_bf16 v[24:27], a[128:131], v[144:147], v[24:27]
    v_mfma_f32_16x16x32_bf16 v[44:47], a[132:135], v[144:147], v[44:47]
    v_mfma_f32_16x16x32_bf16 v[64:67], a[136:139], v[144:147], v[64:67]
    v_mfma_f32_16x16x32_bf16 v[84:87], a[140:143], v[144:147], v[84:87]
    s_waitcnt vmcnt(11)
    s_add_u32 s72, s74, 11
    s_cmp_ge_u32 s72, 16
    s_cselect_b32 s77, 16, 0
    s_sub_u32 s72, s72, s77
    s_mul_i32 s72, s72, 40960
    s_add_u32 s77, s72, s76
    buffer_load_dwordx4 v[136:139], v6, s[32:35], s77 offen offset:0 sc1
    v_mfma_f32_16x16x32_bf16 v[28:31], a[128:131], v[148:151], v[28:31]
    v_mfma_f32_16x16x32_bf16 v[48:51], a[132:135], v[148:151], v[48:51]
    v_mfma_f32_16x16x32_bf16 v[68:71], a[136:139], v[148:151], v[68:71]
    v_mfma_f32_16x16x32_bf16 v[88:91], a[140:143], v[148:151], v[88:91]
    s_waitcnt vmcnt(11)
    buffer_load_dwordx4 v[140:143], v6, s[32:35], s77 offen offset:1024 sc1
    v_mfma_f32_16x16x32_bf16 v[32:35], a[128:131], v[152:155], v[32:35]
    v_mfma_f32_16x16x32_bf16 v[52:55], a[132:135], v[152:155], v[52:55]
    v_mfma_f32_16x16x32_bf16 v[72:75], a[136:139], v[152:155], v[72:75]
    v_mfma_f32_16x16x32_bf16 v[92:95], a[140:143], v[152:155], v[92:95]
    s_waitcnt vmcnt(11)
    buffer_load_dwordx4 v[144:147], v6, s[32:35], s77 offen offset:2048 sc1
    v_mfma_f32_16x16x32_bf16 v[16:19], a[144:147], v[96:99], v[16:19]
    v_mfma_f32_16x16x32_bf16 v[36:39], a[148:151], v[96:99], v[36:39]
    v_mfma_f32_16x16x32_bf16 v[56:59], a[152:155], v[96:99], v[56:59]
    v_mfma_f32_16x16x32_bf16 v[76:79], a[156:159], v[96:99], v[76:79]
    s_waitcnt vmcnt(11)
    buffer_load_dwordx4 v[148:151], v6, s[32:35], s77 offen offset:3072 sc1
    v_mfma_f32_16x16x32_bf16 v[20:23], a[144:147], v[100:103], v[20:23]
    v_mfma_f32_16x16x32_bf16 v[40:43], a[148:151], v[100:103], v[40:43]
    v_mfma_f32_16x16x32_bf16 v[60:63], a[152:155], v[100:103], v[60:63]
    v_mfma_f32_16x16x32_bf16 v[80:83], a[156:159], v[100:103], v[80:83]
    s_waitcnt vmcnt(11)
    buffer_load_dwordx4 v[152:155], v7, s[32:35], s77 offen offset:0 sc1
    v_mfma_f32_16x16x32_bf16 v[24:27], a[144:147], v[104:107], v[24:27]
    v_mfma_f32_16x16x32_bf16 v[44:47], a[148:151], v[104:107], v[44:47]
    v_mfma_f32_16x16x32_bf16 v[64:67], a[152:155], v[104:107], v[64:67]
    v_mfma_f32_16x16x32_bf16 v[84:87], a[156:159], v[104:107], v[84:87]
    s_waitcnt vmcnt(11)
    s_add_u32 s72, s74, 12
    s_cmp_ge_u32 s72, 16
    s_cselect_b32 s77, 16, 0
    s_sub_u32 s72, s72, s77
    s_mul_i32 s72, s72, 40960
    s_add_u32 s77, s72, s76
    buffer_load_dwordx4 v[96:99], v6, s[32:35], s77 offen offset:0 sc1
    v_mfma_f32_16x16x32_bf16 v[28:31], a[144:147], v[108:111], v[28:31]
    v_mfma_f32_16x16x32_bf16 v[48:51], a[148:151], v[108:111], v[48:51]
    v_mfma_f32_16x16x32_bf16 v[68:71], a[152:155], v[108:111], v[68:71]
    v_mfma_f32_16x16x32_bf16 v[88:91], a[156:159], v[108:111], v[88:91]
    s_waitcnt vmcnt(11)
    buffer_load_dwordx4 v[100:103], v6, s[32:35], s77 offen offset:1024 sc1
    v_mfma_f32_16x16x32_bf16 v[32:35], a[144:147], v[112:115], v[32:35]
    v_mfma_f32_16x16x32_bf16 v[52:55], a[148:151], v[112:115], v[52:55]
    v_mfma_f32_16x16x32_bf16 v[72:75], a[152:155], v[112:115], v[72:75]
    v_mfma_f32_16x16x32_bf16 v[92:95], a[156:159], v[112:115], v[92:95]
    s_waitcnt vmcnt(11)
    buffer_load_dwordx4 v[104:107], v6, s[32:35], s77 offen offset:2048 sc1
    v_mfma_f32_16x16x32_bf16 v[16:19], a[160:163], v[116:119], v[16:19]
    v_mfma_f32_16x16x32_bf16 v[36:39], a[164:167], v[116:119], v[36:39]
    v_mfma_f32_16x16x32_bf16 v[56:59], a[168:171], v[116:119], v[56:59]
    v_mfma_f32_16x16x32_bf16 v[76:79], a[172:175], v[116:119], v[76:79]
    s_waitcnt vmcnt(11)
    buffer_load_dwordx4 v[108:111], v6, s[32:35], s77 offen offset:3072 sc1
    v_mfma_f32_16x16x32_bf16 v[20:23], a[160:163], v[120:123], v[20:23]
    v_mfma_f32_16x16x32_bf16 v[40:43], a[164:167], v[120:123], v[40:43]
    v_mfma_f32_16x16x32_bf16 v[60:63], a[168:171], v[120:123], v[60:63]
    v_mfma_f32_16x16x32_bf16 v[80:83], a[172:175], v[120:123], v[80:83]
    s_waitcnt vmcnt(11)
    buffer_load_dwordx4 v[112:115], v7, s[32:35], s77 offen offset:0 sc1
    v_mfma_f32_16x16x32_bf16 v[24:27], a[160:163], v[124:127], v[24:27]
    v_mfma_f32_16x16x32_bf16 v[44:47], a[164:167], v[124:127], v[44:47]
    v_mfma_f32_16x16x32_bf16 v[64:67], a[168:171], v[124:127], v[64:67]
    v_mfma_f32_16x16x32_bf16 v[84:87], a[172:175], v[124:127], v[84:87]
    s_waitcnt vmcnt(11)
    s_add_u32 s72, s74, 13
    s_cmp_ge_u32 s72, 16
    s_cselect_b32 s77, 16, 0
    s_sub_u32 s72, s72, s77
    s_mul_i32 s72, s72, 40960
    s_add_u32 s77, s72, s76
    buffer_load_dwordx4 v[116:119], v6, s[32:35], s77 offen offset:0 sc1
    v_mfma_f32_16x16x32_bf16 v[28:31], a[160:163], v[128:131], v[28:31]
    v_mfma_f32_16x16x32_bf16 v[48:51], a[164:167], v[128:131], v[48:51]
    v_mfma_f32_16x16x32_bf16 v[68:71], a[168:171], v[128:131], v[68:71]
    v_mfma_f32_16x16x32_bf16 v[88:91], a[172:175], v[128:131], v[88:91]
    s_waitcnt vmcnt(11)
    buffer_load_dwordx4 v[120:123], v6, s[32:35], s77 offen offset:1024 sc1
    v_mfma_f32_16x16x32_bf16 v[32:35], a[160:163], v[132:135], v[32:35]
    v_mfma_f32_16x16x32_bf16 v[52:55], a[164:167], v[132:135], v[52:55]
    v_mfma_f32_16x16x32_bf16 v[72:75], a[168:171], v[132:135], v[72:75]
    v_mfma_f32_16x16x32_bf16 v[92:95], a[172:175], v[132:135], v[92:95]
    s_waitcnt vmcnt(11)
    buffer_load_dwordx4 v[124:127], v6, s[32:35], s77 offen offset:2048 sc1
    v_mfma_f32_16x16x32_bf16 v[16:19], a[176:179], v[136:139], v[16:19]
    v_mfma_f32_16x16x32_bf16 v[36:39], a[180:183], v[136:139], v[36:39]
    v_mfma_f32_16x16x32_bf16 v[56:59], a[184:187], v[136:139], v[56:59]
    v_mfma_f32_16x16x32_bf16 v[76:79], a[188:191], v[136:139], v[76:79]
    s_waitcnt vmcnt(11)
    buffer_load_dwordx4 v[128:131], v6, s[32:35], s77 offen offset:3072 sc1
    v_mfma_f32_16x16x32_bf16 v[20:23], a[176:179], v[140:143], v[20:23]
    v_mfma_f32_16x16x32_bf16 v[40:43], a[180:183], v[140:143], v[40:43]
    v_mfma_f32_16x16x32_bf16 v[60:63], a[184:187], v[140:143], v[60:63]
    v_mfma_f32_16x16x32_bf16 v[80:83], a[188:191], v[140:143], v[80:83]
    s_waitcnt vmcnt(11)
    buffer_load_dwordx4 v[132:135], v7, s[32:35], s77 offen offset:0 sc1
    v_mfma_f32_16x16x32_bf16 v[24:27], a[176:179], v[144:147], v[24:27]
    v_mfma_f32_16x16x32_bf16 v[44:47], a[180:183], v[144:147], v[44:47]
    v_mfma_f32_16x16x32_bf16 v[64:67], a[184:187], v[144:147], v[64:67]
    v_mfma_f32_16x16x32_bf16 v[84:87], a[188:191], v[144:147], v[84:87]
    s_waitcnt vmcnt(11)
    s_add_u32 s72, s74, 14
    s_cmp_ge_u32 s72, 16
    s_cselect_b32 s77, 16, 0
    s_sub_u32 s72, s72, s77
    s_mul_i32 s72, s72, 40960
    s_add_u32 s77, s72, s76
    buffer_load_dwordx4 v[136:139], v6, s[32:35], s77 offen offset:0 sc1
    v_mfma_f32_16x16x32_bf16 v[28:31], a[176:179], v[148:151], v[28:31]
    v_mfma_f32_16x16x32_bf16 v[48:51], a[180:183], v[148:151], v[48:51]
    v_mfma_f32_16x16x32_bf16 v[68:71], a[184:187], v[148:151], v[68:71]
    v_mfma_f32_16x16x32_bf16 v[88:91], a[188:191], v[148:151], v[88:91]
    s_waitcnt vmcnt(11)
    buffer_load_dwordx4 v[140:143], v6, s[32:35], s77 offen offset:1024 sc1
    v_mfma_f32_16x16x32_bf16 v[32:35], a[176:179], v[152:155], v[32:35]
    v_mfma_f32_16x16x32_bf16 v[52:55], a[180:183], v[152:155], v[52:55]
    v_mfma_f32_16x16x32_bf16 v[72:75], a[184:187], v[152:155], v[72:75]
    v_mfma_f32_16x16x32_bf16 v[92:95], a[188:191], v[152:155], v[92:95]
    s_waitcnt vmcnt(11)
    buffer_load_dwordx4 v[144:147], v6, s[32:35], s77 offen offset:2048 sc1
    v_mfma_f32_16x16x32_bf16 v[16:19], a[192:195], v[96:99], v[16:19]
    v_mfma_f32_16x16x32_bf16 v[36:39], a[196:199], v[96:99], v[36:39]
    v_mfma_f32_16x16x32_bf16 v[56:59], a[200:203], v[96:99], v[56:59]
    v_mfma_f32_16x16x32_bf16 v[76:79], a[204:207], v[96:99], v[76:79]
    s_waitcnt vmcnt(11)
    buffer_load_dwordx4 v[148:151], v6, s[32:35], s77 offen offset:3072 sc1
    v_mfma_f32_16x16x32_bf16 v[20:23], a[192:195], v[100:103], v[20:23]
    v_mfma_f32_16x16x32_bf16 v[40:43], a[196:199], v[100:103], v[40:43]
    v_mfma_f32_16x16x32_bf16 v[60:63], a[200:203], v[100:103], v[60:63]
    v_mfma_f32_16x16x32_bf16 v[80:83], a[204:207], v[100:103], v[80:83]
    s_waitcnt vmcnt(11)
    buffer_load_dwordx4 v[152:155], v7, s[32:35], s77 offen offset:0 sc1
    v_mfma_f32_16x16x32_bf16 v[24:27], a[192:195], v[104:107], v[24:27]
    v_mfma_f32_16x16x32_bf16 v[44:47], a[196:199], v[104:107], v[44:47]
    v_mfma_f32_16x16x32_bf16 v[64:67], a[200:203], v[104:107], v[64:67]
    v_mfma_f32_16x16x32_bf16 v[84:87], a[204:207], v[104:107], v[84:87]
    s_waitcnt vmcnt(11)
    s_add_u32 s72, s74, 15
    s_cmp_ge_u32 s72, 16
    s_cselect_b32 s77, 16, 0
    s_sub_u32 s72, s72, s77
    s_mul_i32 s72, s72, 40960
    s_add_u32 s77, s72, s76
    buffer_load_dwordx4 v[96:99], v6, s[32:35], s77 offen offset:0 sc1
    v_mfma_f32_16x16x32_bf16 v[28:31], a[192:195], v[108:111], v[28:31]
    v_mfma_f32_16x16x32_bf16 v[48:51], a[196:199], v[108:111], v[48:51]
    v_mfma_f32_16x16x32_bf16 v[68:71], a[200:203], v[108:111], v[68:71]
    v_mfma_f32_16x16x32_bf16 v[88:91], a[204:207], v[108:111], v[88:91]
    s_waitcnt vmcnt(11)
    buffer_load_dwordx4 v[100:103], v6, s[32:35], s77 offen offset:1024 sc1
    v_mfma_f32_16x16x32_bf16 v[32:35], a[192:195], v[112:115], v[32:35]
    v_mfma_f32_16x16x32_bf16 v[52:55], a[196:199], v[112:115], v[52:55]
    v_mfma_f32_16x16x32_bf16 v[72:75], a[200:203], v[112:115], v[72:75]
    v_mfma_f32_16x16x32_bf16 v[92:95], a[204:207], v[112:115], v[92:95]
    s_waitcnt vmcnt(11)
    buffer_load_dwordx4 v[104:107], v6, s[32:35], s77 offen offset:2048 sc1
    v_mfma_f32_16x16x32_bf16 v[16:19], a[208:211], v[116:119], v[16:19]
    v_mfma_f32_16x16x32_bf16 v[36:39], a[212:215], v[116:119], v[36:39]
    v_mfma_f32_16x16x32_bf16 v[56:59], a[216:219], v[116:119], v[56:59]
    v_mfma_f32_16x16x32_bf16 v[76:79], a[220:223], v[116:119], v[76:79]
    s_add_u32 m0, s78, 0
    s_add_u32 s72, s75, 0
    s_cmp_ge_u32 s72, 14
    s_cselect_b32 s71, 14, 0
    s_sub_u32 s72, s72, s71
    s_mul_i32 s72, s72, 131072
    s_add_u32 s71, s72, s3
    s_waitcnt vmcnt(11)
    buffer_load_dwordx4 v[108:111], v6, s[32:35], s77 offen offset:3072 sc1
    v_mfma_f32_16x16x32_bf16 v[20:23], a[208:211], v[120:123], v[20:23]
    v_mfma_f32_16x16x32_bf16 v[40:43], a[212:215], v[120:123], v[40:43]
    v_mfma_f32_16x16x32_bf16 v[60:63], a[216:219], v[120:123], v[60:63]
    v_mfma_f32_16x16x32_bf16 v[80:83], a[220:223], v[120:123], v[80:83]
    buffer_load_dwordx4 v220, s[28:31], s71 offen offset:0  lds
    s_waitcnt vmcnt(12)
    buffer_load_dwordx4 v[112:115], v7, s[32:35], s77 offen offset:0 sc1
    v_mfma_f32_16x16x32_bf16 v[24:27], a[208:211], v[124:127], v[24:27]
    v_mfma_f32_16x16x32_bf16 v[44:47], a[212:215], v[124:127], v[44:47]
    v_mfma_f32_16x16x32_bf16 v[64:67], a[216:219], v[124:127], v[64:67]
    v_mfma_f32_16x16x32_bf16 v[84:87], a[220:223], v[124:127], v[84:87]
    buffer_load_dwordx4 v221, s[28:31], s71 offen offset:1024  lds
    s_waitcnt vmcnt(13)
    v_mfma_f32_16x16x32_bf16 v[28:31], a[208:211], v[128:131], v[28:31]
    v_mfma_f32_16x16x32_bf16 v[48:51], a[212:215], v[128:131], v[48:51]
    v_mfma_f32_16x16x32_bf16 v[68:71], a[216:219], v[128:131], v[68:71]
    v_mfma_f32_16x16x32_bf16 v[88:91], a[220:223], v[128:131], v[88:91]
    buffer_load_dwordx4 v222, s[28:31], s71 offen offset:2048  lds
    s_waitcnt vmcnt(13)
    v_mfma_f32_16x16x32_bf16 v[32:35], a[208:211], v[132:135], v[32:35]
    v_mfma_f32_16x16x32_bf16 v[52:55], a[212:215], v[132:135], v[52:55]
    v_mfma_f32_16x16x32_bf16 v[72:75], a[216:219], v[132:135], v[72:75]
    v_mfma_f32_16x16x32_bf16 v[92:95], a[220:223], v[132:135], v[92:95]
    buffer_load_dwordx4 v223, s[28:31], s71 offen offset:3072  lds
    s_mov_b32 s100, 0xbdd2d3e8
    s_mov_b32 s101, 0xbdd2d3e8
    v_mov_b32 v204, 0xc0135761
    v_mov_b32 v205, 0xc0135761
    s_cmp_lg_u32 s60, 0
    s_cbranch_scc1 L_ep1_1
    s_waitcnt vmcnt(13)
    s_waitcnt vmcnt(8)
    v_mfma_f32_16x16x32_bf16 v[56:59], a[232:235], v[136:139], v[56:59]
    s_add_u32 m0, s78, 4096
    s_add_u32 s72, s75, 1
    s_cmp_ge_u32 s72, 14
    s_cselect_b32 s71, 14, 0
    s_sub_u32 s72, s72, s71
    s_mul_i32 s72, s72, 131072
    s_add_u32 s71, s72, s3
    v_mfma_f32_16x16x32_bf16 v[76:79], a[236:239], v[136:139], v[76:79]
    buffer_load_dwordx4 v220, s[28:31], s71 offen offset:0  lds
    v_mfma_f32_16x16x32_bf16 v[56:59], a[248:251], v[96:99], v[56:59]
    buffer_load_dwordx4 v221, s[28:31], s71 offen offset:1024  lds
    v_mfma_f32_16x16x32_bf16 v[76:79], a[252:255], v[96:99], v[76:79]
    buffer_load_dwordx4 v222, s[28:31], s71 offen offset:2048  lds
    s_waitcnt vmcnt(10)
    v_mfma_f32_16x16x32_bf16 v[60:63], a[232:235], v[140:143], v[60:63]
    buffer_load_dwordx4 v223, s[28:31], s71 offen offset:3072  lds
    v_mfma_f32_16x16x32_bf16 v[80:83], a[236:239], v[140:143], v[80:83]
    s_add_u32 m0, s78, 8192
    s_add_u32 s72, s75, 2
    s_cmp_ge_u32 s72, 14
    s_cselect_b32 s71, 14, 0
    s_sub_u32 s72, s72, s71
    s_mul_i32 s72, s72, 131072
    s_add_u32 s71, s72, s3
    v_mfma_f32_16x16x32_bf16 v[60:63], a[248:251], v[100:103], v[60:63]
    buffer_load_dwordx4 v220, s[28:31], s71 offen offset:0  lds
    v_mfma_f32_16x16x32_bf16 v[80:83], a[252:255], v[100:103], v[80:83]
    ds_write_b128 v200, v[56:59] offset:28672
    s_waitcnt vmcnt(11)
    v_mfma_f32_16x16x32_bf16 v[64:67], a[232:235], v[144:147], v[64:67]
    ds_write_b128 v200, v[76:79] offset:29696
    v_mfma_f32_16x16x32_bf16 v[84:87], a[236:239], v[144:147], v[84:87]
    buffer_load_dwordx4 v221, s[28:31], s71 offen offset:1024  lds
    v_mfma_f32_16x16x32_bf16 v[64:67], a[248:251], v[104:107], v[64:67]
    buffer_load_dwordx4 v222, s[28:31], s71 offen offset:2048  lds
    v_mfma_f32_16x16x32_bf16 v[84:87], a[252:255], v[104:107], v[84:87]
    ds_write_b128 v200, v[60:63] offset:30720
    s_waitcnt vmcnt(12)
    v_mfma_f32_16x16x32_bf16 v[28:31], a[224:227], v[148:151], v[28:31]
    ds_write_b128 v200, v[80:83] offset:31744
    v_mfma_f32_16x16x32_bf16 v[48:51], a[228:231], v[148:151], v[48:51]
    buffer_load_dwordx4 v223, s[28:31], s71 offen offset:3072  lds
    v_mfma_f32_16x16x32_bf16 v[28:31], a[240:243], v[108:111], v[28:31]
    v_mfma_f32_16x16x32_bf16 v[48:51], a[244:247], v[108:111], v[48:51]
    ds_write_b128 v202, v[64:67] offset:0
    v_mfma_f32_16x16x32_bf16 v[68:71], a[232:235], v[148:151], v[68:71]
    ds_write_b128 v202, v[84:87] offset:1024
    v_mfma_f32_16x16x32_bf16 v[88:91], a[236:239], v[148:151], v[88:91]
    v_mfma_f32_16x16x32_bf16 v[68:71], a[248:251], v[108:111], v[68:71]
    v_mfma_f32_16x16x32_bf16 v[88:91], a[252:255], v[108:111], v[88:91]
    s_waitcnt vmcnt(11)
    v_mfma_f32_16x16x32_bf16 v[32:35], a[224:227], v[152:155], v[32:35]
    v_mfma_f32_16x16x32_bf16 v[52:55], a[228:231], v[152:155], v[52:55]
    ds_write_b128 v200, v[28:31] offset:24576
    v_mfma_f32_16x16x32_bf16 v[32:35], a[240:243], v[112:115], v[32:35]
    ds_write_b128 v200, v[48:51] offset:25600
    v_mfma_f32_16x16x32_bf16 v[52:55], a[244:247], v[112:115], v[52:55]
    v_mfma_f32_16x16x32_bf16 v[72:75], a[232:235], v[152:155], v[72:75]
    v_mfma_f32_16x16x32_bf16 v[92:95], a[236:239], v[152:155], v[92:95]
    ds_write_b128 v202, v[68:71] offset:2048
    v_mfma_f32_16x16x32_bf16 v[72:75], a[248:251], v[112:115], v[72:75]
    ds_write_b128 v202, v[88:91] offset:3072
    v_mfma_f32_16x16x32_bf16 v[92:95], a[252:255], v[112:115], v[92:95]
    v_mfma_f32_16x16x32_bf16 v[16:19], a[224:227], v[136:139], v[16:19]
    ds_write_b128 v200, v[32:35] offset:26624
    v_mfma_f32_16x16x32_bf16 v[36:39], a[228:231], v[136:139], v[36:39]
    ds_write_b128 v200, v[52:55] offset:27648
    v_mfma_f32_16x16x32_bf16 v[16:19], a[240:243], v[96:99], v[16:19]
    v_mfma_f32_16x16x32_bf16 v[36:39], a[244:247], v[96:99], v[36:39]
    v_mfma_f32_16x16x32_bf16 v[20:23], a[224:227], v[140:143], v[20:23]
    ds_write_b128 v202, v[72:75] offset:4096
    v_mfma_f32_16x16x32_bf16 v[40:43], a[228:231], v[140:143], v[40:43]
    ds_write_b128 v202, v[92:95] offset:5120
    v_mfma_f32_16x16x32_bf16 v[20:23], a[240:243], v[100:103], v[20:23]
    v_mfma_f32_16x16x32_bf16 v[40:43], a[244:247], v[100:103], v[40:43]
    v_mfma_f32_16x16x32_bf16 v[24:27], a[224:227], v[144:147], v[24:27]
    v_mfma_f32_16x16x32_bf16 v[44:47], a[228:231], v[144:147], v[44:47]
    v_mfma_f32_16x16x32_bf16 v[24:27], a[240:243], v[104:107], v[24:27]
    v_mfma_f32_16x16x32_bf16 v[44:47], a[244:247], v[104:107], v[44:47]
    s_add_u32 m0, s78, 12288
    s_add_u32 s72, s75, 3
    s_cmp_ge_u32 s72, 14
    s_cselect_b32 s77, 14, 0
    s_sub_u32 s72, s72, s77
    s_mul_i32 s72, s72, 131072
    s_add_u32 s77, s72, s3
    buffer_load_dwordx4 v220, s[28:31], s77 offen offset:0  lds
    buffer_load_dwordx4 v221, s[28:31], s77 offen offset:1024  lds
    buffer_load_dwordx4 v222, s[28:31], s77 offen offset:2048  lds
    buffer_load_dwordx4 v223, s[28:31], s77 offen offset:3072  lds
    s_waitcnt lgkmcnt(0)
    s_barrier
    ds_read_b128 v[96:99], v200 offset:57344
    ds_read_b128 v[100:103], v200 offset:58368
    ds_read_b128 v[104:107], v201 offset:24576
    ds_read_b128 v[108:111], v201 offset:25600
    ds_read_b128 v[112:115], v201 offset:57344
    ds_read_b128 v[116:119], v201 offset:58368
    ds_read_b128 v[120:123], v200 offset:59392
    ds_read_b128 v[124:127], v200 offset:60416
    ds_read_b128 v[128:131], v201 offset:26624
    ds_read_b128 v[132:135], v201 offset:27648
    ds_read_b128 v[136:139], v201 offset:59392
    ds_read_b128 v[140:143], v201 offset:60416
    ds_read_b128 v[144:147], v200 offset:61440
    ds_read_b128 v[148:151], v200 offset:62464
    ds_read_b128 v[152:155], v201 offset:28672
    ds_read_b128 v[156:159], v201 offset:29696
    ds_read_b128 v[160:163], v201 offset:61440
    ds_read_b128 v[164:167], v201 offset:62464
    v_lshlrev_b32 v206, 16, v10
    v_and_b32 v207, 0xffff0000, v10
    v_lshlrev_b32 v208, 16, v11
    v_and_b32 v209, 0xffff0000, v11
    v_lshlrev_b32 v210, 16, v12
    v_and_b32 v211, 0xffff0000, v12
    v_lshlrev_b32 v212, 16, v13
    v_and_b32 v213, 0xffff0000, v13
    v_pk_add_f32 v[16:17], v[16:17], v[206:207]
    v_pk_add_f32 v[18:19], v[18:19], v[208:209]
    v_pk_add_f32 v[36:37], v[36:37], v[210:211]
    v_pk_add_f32 v[38:39], v[38:39], v[212:213]
    v_pk_add_f32 v[20:21], v[20:21], v[206:207]
    v_pk_add_f32 v[22:23], v[22:23], v[208:209]
    v_pk_add_f32 v[40:41], v[40:41], v[210:211]
    v_pk_add_f32 v[42:43], v[42:43], v[212:213]
    v_pk_add_f32 v[24:25], v[24:25], v[206:207]
    v_pk_add_f32 v[26:27], v[26:27], v[208:209]
    v_pk_add_f32 v[44:45], v[44:45], v[210:211]
    v_pk_add_f32 v[46:47], v[46:47], v[212:213]
    s_waitcnt lgkmcnt(15)
    v_pk_add_f32 v[16:17], v[16:17], v[96:97]
    v_pk_add_f32 v[18:19], v[18:19], v[98:99]
    s_waitcnt lgkmcnt(15)
    v_pk_add_f32 v[36:37], v[36:37], v[100:101]
    v_pk_add_f32 v[38:39], v[38:39], v[102:103]
    s_waitcnt lgkmcnt(15)
    v_pk_add_f32 v[16:17], v[16:17], v[104:105]
    v_pk_add_f32 v[18:19], v[18:19], v[106:107]
    s_waitcnt lgkmcnt(14)
    v_pk_add_f32 v[36:37], v[36:37], v[108:109]
    v_pk_add_f32 v[38:39], v[38:39], v[110:111]
    s_waitcnt lgkmcnt(13)
    v_pk_add_f32 v[16:17], v[16:17], v[112:113]
    v_pk_add_f32 v[18:19], v[18:19], v[114:115]
    s_waitcnt lgkmcnt(12)
    v_pk_add_f32 v[36:37], v[36:37], v[116:117]
    v_pk_add_f32 v[38:39], v[38:39], v[118:119]
    s_waitcnt lgkmcnt(11)
    v_pk_add_f32 v[20:21], v[20:21], v[120:121]
    v_pk_add_f32 v[22:23], v[22:23], v[122:123]
    s_waitcnt lgkmcnt(10)
    v_pk_add_f32 v[40:41], v[40:41], v[124:125]
    v_pk_add_f32 v[42:43], v[42:43], v[126:127]
    s_waitcnt lgkmcnt(9)
    v_pk_add_f32 v[20:21], v[20:21], v[128:129]
    v_pk_add_f32 v[22:23], v[22:23], v[130:131]
    s_waitcnt lgkmcnt(8)
    v_pk_add_f32 v[40:41], v[40:41], v[132:133]
    v_pk_add_f32 v[42:43], v[42:43], v[134:135]
    s_waitcnt lgkmcnt(7)
    v_pk_add_f32 v[20:21], v[20:21], v[136:137]
    v_pk_add_f32 v[22:23], v[22:23], v[138:139]
    s_waitcnt lgkmcnt(6)
    v_pk_add_f32 v[40:41], v[40:41], v[140:141]
    v_pk_add_f32 v[42:43], v[42:43], v[142:143]
    s_waitcnt lgkmcnt(5)
    v_pk_add_f32 v[24:25], v[24:25], v[144:145]
    v_pk_add_f32 v[26:27], v[26:27], v[146:147]
    s_waitcnt lgkmcnt(4)
    v_pk_add_f32 v[44:45], v[44:45], v[148:149]
    v_pk_add_f32 v[46:47], v[46:47], v[150:151]
    s_waitcnt lgkmcnt(3)
    v_pk_add_f32 v[24:25], v[24:25], v[152:153]
    v_pk_add_f32 v[26:27], v[26:27], v[154:155]
    s_waitcnt lgkmcnt(2)
    v_pk_add_f32 v[44:45], v[44:45], v[156:157]
    v_pk_add_f32 v[46:47], v[46:47], v[158:159]
    s_waitcnt lgkmcnt(1)
    v_pk_add_f32 v[24:25], v[24:25], v[160:161]
    v_pk_add_f32 v[26:27], v[26:27], v[162:163]
    s_waitcnt lgkmcnt(0)
    v_pk_add_f32 v[44:45], v[44:45], v[164:165]
    v_pk_add_f32 v[46:47], v[46:47], v[166:167]
    s_barrier
    v_pk_mul_f32 v[96:97], v[16:17], v[16:17]
    v_pk_mul_f32 v[98:99], v[18:19], v[18:19]
    v_pk_mul_f32 v[100:101], v[36:37], v[36:37]
    v_pk_mul_f32 v[102:103], v[38:39], v[38:39]
    v_pk_mul_f32 v[104:105], v[20:21], v[20:21]
    v_pk_mul_f32 v[106:107], v[22:23], v[22:23]
    v_pk_mul_f32 v[108:109], v[40:41], v[40:41]
    v_pk_mul_f32 v[110:111], v[42:43], v[42:43]
    v_pk_mul_f32 v[112:113], v[24:25], v[24:25]
    v_pk_mul_f32 v[114:115], v[26:27], v[26:27]
    v_pk_mul_f32 v[116:117], v[44:45], v[44:45]
    v_pk_mul_f32 v[118:119], v[46:47], v[46:47]
    v_pk_fma_f32 v[96:97], v[96:97], s[100:101], v[204:205]
    v_pk_fma_f32 v[98:99], v[98:99], s[100:101], v[204:205]
    v_pk_fma_f32 v[100:101], v[100:101], s[100:101], v[204:205]
    v_pk_fma_f32 v[102:103], v[102:103], s[100:101], v[204:205]
    v_pk_fma_f32 v[104:105], v[104:105], s[100:101], v[204:205]
    v_pk_fma_f32 v[106:107], v[106:107], s[100:101], v[204:205]
    v_pk_fma_f32 v[108:109], v[108:109], s[100:101], v[204:205]
    v_pk_fma_f32 v[110:111], v[110:111], s[100:101], v[204:205]
    v_pk_fma_f32 v[112:113], v[112:113], s[100:101], v[204:205]
    v_pk_fma_f32 v[114:115], v[114:115], s[100:101], v[204:205]
    v_pk_fma_f32 v[116:117], v[116:117], s[100:101], v[204:205]
    v_pk_fma_f32 v[118:119], v[118:119], s[100:101], v[204:205]
    v_pk_mul_f32 v[96:97], v[96:97], v[16:17]
    v_pk_mul_f32 v[98:99], v[98:99], v[18:19]
    v_pk_mul_f32 v[100:101], v[100:101], v[36:37]
    v_pk_mul_f32 v[102:103], v[102:103], v[38:39]
    v_pk_mul_f32 v[104:105], v[104:105], v[20:21]
    v_pk_mul_f32 v[106:107], v[106:107], v[22:23]
    v_pk_mul_f32 v[108:109], v[108:109], v[40:41]
    v_pk_mul_f32 v[110:111], v[110:111], v[42:43]
    v_pk_mul_f32 v[112:113], v[112:113], v[24:25]
    v_pk_mul_f32 v[114:115], v[114:115], v[26:27]
    v_pk_mul_f32 v[116:117], v[116:117], v[44:45]
    v_pk_mul_f32 v[118:119], v[118:119], v[46:47]
    v_exp_f32 v96, v96
    v_exp_f32 v97, v97
    v_exp_f32 v98, v98
    v_exp_f32 v99, v99
    v_exp_f32 v100, v100
    v_exp_f32 v101, v101
    v_exp_f32 v102, v102
    v_exp_f32 v103, v103
    v_exp_f32 v104, v104
    v_exp_f32 v105, v105
    v_exp_f32 v106, v106
    v_exp_f32 v107, v107
    v_exp_f32 v108, v108
    v_exp_f32 v109, v109
    v_exp_f32 v110, v110
    v_exp_f32 v111, v111
    v_exp_f32 v112, v112
    v_exp_f32 v113, v113
    v_exp_f32 v114, v114
    v_exp_f32 v115, v115
    v_exp_f32 v116, v116
    v_exp_f32 v117, v117
    v_exp_f32 v118, v118
    v_exp_f32 v119, v119
    v_pk_add_f32 v[96:97], v[96:97], 1.0 op_sel_hi:[1,0]
    v_pk_add_f32 v[98:99], v[98:99], 1.0 op_sel_hi:[1,0]
    v_pk_add_f32 v[100:101], v[100:101], 1.0 op_sel_hi:[1,0]
    v_pk_add_f32 v[102:103], v[102:103], 1.0 op_sel_hi:[1,0]
    v_pk_add_f32 v[104:105], v[104:105], 1.0 op_sel_hi:[1,0]
    v_pk_add_f32 v[106:107], v[106:107], 1.0 op_sel_hi:[1,0]
    v_pk_add_f32 v[108:109], v[108:109], 1.0 op_sel_hi:[1,0]
    v_pk_add_f32 v[110:111], v[110:111], 1.0 op_sel_hi:[1,0]
    v_pk_add_f32 v[112:113], v[112:113], 1.0 op_sel_hi:[1,0]
    v_pk_add_f32 v[114:115], v[114:115], 1.0 op_sel_hi:[1,0]
    v_pk_add_f32 v[116:117], v[116:117], 1.0 op_sel_hi:[1,0]
    v_pk_add_f32 v[118:119], v[118:119], 1.0 op_sel_hi:[1,0]
    v_rcp_f32 v96, v96
    v_rcp_f32 v97, v97
    v_rcp_f32 v98, v98
    v_rcp_f32 v99, v99
    v_rcp_f32 v100, v100
    v_rcp_f32 v101, v101
    v_rcp_f32 v102, v102
    v_rcp_f32 v103, v103
    v_rcp_f32 v104, v104
    v_rcp_f32 v105, v105
    v_rcp_f32 v106, v106
    v_rcp_f32 v107, v107
    v_rcp_f32 v108, v108
    v_rcp_f32 v109, v109
    v_rcp_f32 v110, v110
    v_rcp_f32 v111, v111
    v_rcp_f32 v112, v112
    v_rcp_f32 v113, v113
    v_rcp_f32 v114, v114
    v_rcp_f32 v115, v115
    v_rcp_f32 v116, v116
    v_rcp_f32 v117, v117
    v_rcp_f32 v118, v118
    v_rcp_f32 v119, v119
    s_nop 0
    v_pk_mul_f32 v[16:17], v[16:17], v[96:97]
    v_pk_mul_f32 v[18:19], v[18:19], v[98:99]
    v_pk_mul_f32 v[36:37], v[36:37], v[100:101]
    v_pk_mul_f32 v[38:39], v[38:39], v[102:103]
    v_pk_mul_f32 v[20:21], v[20:21], v[104:105]
    v_pk_mul_f32 v[22:23], v[22:23], v[106:107]
    v_pk_mul_f32 v[40:41], v[40:41], v[108:109]
    v_pk_mul_f32 v[42:43], v[42:43], v[110:111]
    v_pk_mul_f32 v[24:25], v[24:25], v[112:113]
    v_pk_mul_f32 v[26:27], v[26:27], v[114:115]
    v_pk_mul_f32 v[44:45], v[44:45], v[116:117]
    v_pk_mul_f32 v[46:47], v[46:47], v[118:119]
    s_lshl_b32 s68, s63, 1
    s_add_u32 s68, s68, 0
    s_mul_i32 s68, s68, 40960
    s_mul_i32 s69, s64, 5120
    s_add_u32 s68, s68, s69
    v_cvt_pk_bf16_f32 v160, v16, v17
    v_cvt_pk_bf16_f32 v161, v18, v19
    v_cvt_pk_bf16_f32 v162, v36, v37
    v_cvt_pk_bf16_f32 v163, v38, v39
    s_add_u32 s69, s68, 0
    buffer_store_dwordx4 v[160:163], v200, s[36:39], s69 offen sc1
    v_cvt_pk_bf16_f32 v164, v20, v21
    v_cvt_pk_bf16_f32 v165, v22, v23
    v_cvt_pk_bf16_f32 v166, v40, v41
    v_cvt_pk_bf16_f32 v167, v42, v43
    s_add_u32 s69, s68, 1024
    buffer_store_dwordx4 v[164:167], v200, s[36:39], s69 offen sc1
    v_cvt_pk_bf16_f32 v168, v24, v25
    v_cvt_pk_bf16_f32 v169, v26, v27
    v_cvt_pk_bf16_f32 v170, v44, v45
    v_cvt_pk_bf16_f32 v171, v46, v47
    s_add_u32 s69, s68, 2048
    buffer_store_dwordx4 v[168:171], v200, s[36:39], s69 offen sc1
    s_add_u32 m0, s78, 16384
    s_add_u32 s72, s75, 4
    s_cmp_ge_u32 s72, 14
    s_cselect_b32 s77, 14, 0
    s_sub_u32 s72, s72, s77
    s_mul_i32 s72, s72, 131072
    s_add_u32 s77, s72, s3
    buffer_load_dwordx4 v220, s[28:31], s77 offen offset:0  lds
    buffer_load_dwordx4 v221, s[28:31], s77 offen offset:1024  lds
    buffer_load_dwordx4 v222, s[28:31], s77 offen offset:2048  lds
    buffer_load_dwordx4 v223, s[28:31], s77 offen offset:3072  lds
    s_add_u32 m0, s78, 20480
    s_add_u32 s72, s75, 5
    s_cmp_ge_u32 s72, 14
    s_cselect_b32 s77, 14, 0
    s_sub_u32 s72, s72, s77
    s_mul_i32 s72, s72, 131072
    s_add_u32 s77, s72, s3
    buffer_load_dwordx4 v220, s[28:31], s77 offen offset:0  lds
    buffer_load_dwordx4 v221, s[28:31], s77 offen offset:1024  lds
    buffer_load_dwordx4 v222, s[28:31], s77 offen offset:2048  lds
    buffer_load_dwordx4 v223, s[28:31], s77 offen offset:3072  lds
    s_waitcnt vmcnt(11)
    ds_read_b64_tr_b16 a[0:1], v2 offset:0
    ds_read_b64_tr_b16 a[2:3], v2 offset:2048
    ds_read_b64_tr_b16 a[4:5], v3 offset:0
    ds_read_b64_tr_b16 a[6:7], v3 offset:2048
    ds_read_b64_tr_b16 a[8:9], v4 offset:0
    ds_read_b64_tr_b16 a[10:11], v4 offset:2048
    ds_read_b64_tr_b16 a[12:13], v5 offset:0
    ds_read_b64_tr_b16 a[14:15], v5 offset:2048
    ds_read_b64_tr_b16 a[16:17], v2 offset:4096
    ds_read_b64_tr_b16 a[18:19], v2 offset:6144
    ds_read_b64_tr_b16 a[20:21], v3 offset:4096
    ds_read_b64_tr_b16 a[22:23], v3 offset:6144
    ds_read_b64_tr_b16 a[24:25], v4 offset:4096
    ds_read_b64_tr_b16 a[26:27], v4 offset:6144
    ds_read_b64_tr_b16 a[28:29], v5 offset:4096
    ds_read_b64_tr_b16 a[30:31], v5 offset:6144
    s_waitcnt lgkmcnt(0)
    ds_read_b64_tr_b16 a[32:33], v2 offset:8192
    ds_read_b64_tr_b16 a[34:35], v2 offset:10240
    ds_read_b64_tr_b16 a[36:37], v3 offset:8192
    ds_read_b64_tr_b16 a[38:39], v3 offset:10240
    ds_read_b64_tr_b16 a[40:41], v4 offset:8192
    ds_read_b64_tr_b16 a[42:43], v4 offset:10240
    ds_read_b64_tr_b16 a[44:45], v5 offset:8192
    ds_read_b64_tr_b16 a[46:47], v5 offset:10240
    ds_read_b64_tr_b16 a[48:49], v2 offset:12288
    ds_read_b64_tr_b16 a[50:51], v2 offset:14336
    ds_read_b64_tr_b16 a[52:53], v3 offset:12288
    ds_read_b64_tr_b16 a[54:55], v3 offset:14336
    ds_read_b64_tr_b16 a[56:57], v4 offset:12288
    ds_read_b64_tr_b16 a[58:59], v4 offset:14336
    ds_read_b64_tr_b16 a[60:61], v5 offset:12288
    ds_read_b64_tr_b16 a[62:63], v5 offset:14336
    s_waitcnt lgkmcnt(0)
    s_waitcnt vmcnt(8)
    s_barrier
    s_lshl_b32 s68, s64, 5
    s_add_u32 s68, s68, s63
    s_mul_i32 s68, s68, 256
    s_add_u32 s68, s68, 65536
    v_mov_b32 v15, s68
    v_mov_b32 v9, s67
    s_mov_b64 s[80:81], exec
    s_mov_b64 exec, 1
    buffer_store_dword v9, v15, s[44:47], 0 offen sc1
    s_mov_b64 exec, s[80:81]
    s_add_u32 m0, s78, 24576
    s_add_u32 s72, s75, 6
    s_cmp_ge_u32 s72, 14
    s_cselect_b32 s77, 14, 0
    s_sub_u32 s72, s72, s77
    s_mul_i32 s72, s72, 131072
    s_add_u32 s77, s72, s3
    buffer_load_dwordx4 v220, s[28:31], s77 offen offset:0  lds
    buffer_load_dwordx4 v221, s[28:31], s77 offen offset:1024  lds
    buffer_load_dwordx4 v222, s[28:31], s77 offen offset:2048  lds
    buffer_load_dwordx4 v223, s[28:31], s77 offen offset:3072  lds
    s_add_u32 m0, s78, 28672
    s_add_u32 s72, s75, 7
    s_cmp_ge_u32 s72, 14
    s_cselect_b32 s77, 14, 0
    s_sub_u32 s72, s72, s77
    s_mul_i32 s72, s72, 131072
    s_add_u32 s77, s72, s3
    buffer_load_dwordx4 v220, s[28:31], s77 offen offset:0  lds
    buffer_load_dwordx4 v221, s[28:31], s77 offen offset:1024  lds
    buffer_load_dwordx4 v222, s[28:31], s77 offen offset:2048  lds
    buffer_load_dwordx4 v223, s[28:31], s77 offen offset:3072  lds
    s_add_u32 m0, s99, 0
    s_add_u32 s72, s75, 8
    s_cmp_ge_u32 s72, 14
    s_cselect_b32 s77, 14, 0
    s_sub_u32 s72, s72, s77
    s_mul_i32 s72, s72, 131072
    s_add_u32 s77, s72, s3
    buffer_load_dwordx4 v220, s[28:31], s77 offen offset:0  lds
    buffer_load_dwordx4 v221, s[28:31], s77 offen offset:1024  lds
    buffer_load_dwordx4 v222, s[28:31], s77 offen offset:2048  lds
    buffer_load_dwordx4 v223, s[28:31], s77 offen offset:3072  lds
    s_add_u32 m0, s99, 4096
    s_add_u32 s72, s75, 9
    s_cmp_ge_u32 s72, 14
    s_cselect_b32 s77, 14, 0
    s_sub_u32 s72, s72, s77
    s_mul_i32 s72, s72, 131072
    s_add_u32 s77, s72, s3
    buffer_load_dwordx4 v220, s[28:31], s77 offen offset:0  lds
    buffer_load_dwordx4 v221, s[28:31], s77 offen offset:1024  lds
    buffer_load_dwordx4 v222, s[28:31], s77 offen offset:2048  lds
    buffer_load_dwordx4 v223, s[28:31], s77 offen offset:3072  lds
    s_add_u32 m0, s78, 0
    s_add_u32 s72, s75, 10
    s_cmp_ge_u32 s72, 14
    s_cselect_b32 s77, 14, 0
    s_sub_u32 s72, s72, s77
    s_mul_i32 s72, s72, 131072
    s_add_u32 s77, s72, s3
    buffer_load_dwordx4 v220, s[28:31], s77 offen offset:0  lds
    buffer_load_dwordx4 v221, s[28:31], s77 offen offset:1024  lds
    buffer_load_dwordx4 v222, s[28:31], s77 offen offset:2048  lds
    buffer_load_dwordx4 v223, s[28:31], s77 offen offset:3072  lds
    s_add_u32 m0, s78, 4096
    s_add_u32 s72, s75, 11
    s_cmp_ge_u32 s72, 14
    s_cselect_b32 s77, 14, 0
    s_sub_u32 s72, s72, s77
    s_mul_i32 s72, s72, 131072
    s_add_u32 s77, s72, s3
    buffer_load_dwordx4 v220, s[28:31], s77 offen offset:0  lds
    buffer_load_dwordx4 v221, s[28:31], s77 offen offset:1024  lds
    buffer_load_dwordx4 v222, s[28:31], s77 offen offset:2048  lds
    buffer_load_dwordx4 v223, s[28:31], s77 offen offset:3072  lds
    s_add_u32 m0, s78, 8192
    s_add_u32 s72, s75, 12
    s_cmp_ge_u32 s72, 14
    s_cselect_b32 s77, 14, 0
    s_sub_u32 s72, s72, s77
    s_mul_i32 s72, s72, 131072
    s_add_u32 s77, s72, s3
    buffer_load_dwordx4 v220, s[28:31], s77 offen offset:0  lds
    buffer_load_dwordx4 v221, s[28:31], s77 offen offset:1024  lds
    buffer_load_dwordx4 v222, s[28:31], s77 offen offset:2048  lds
    buffer_load_dwordx4 v223, s[28:31], s77 offen offset:3072  lds
    s_add_u32 m0, s78, 12288
    s_add_u32 s72, s75, 13
    s_cmp_ge_u32 s72, 14
    s_cselect_b32 s77, 14, 0
    s_sub_u32 s72, s72, s77
    s_mul_i32 s72, s72, 131072
    s_add_u32 s77, s72, s3
    buffer_load_dwordx4 v220, s[28:31], s77 offen offset:0  lds
    buffer_load_dwordx4 v221, s[28:31], s77 offen offset:1024  lds
    buffer_load_dwordx4 v222, s[28:31], s77 offen offset:2048  lds
    buffer_load_dwordx4 v223, s[28:31], s77 offen offset:3072  lds
    s_waitcnt vmcnt(36)
    ds_read_b64_tr_b16 a[64:65], v2 offset:16384
    ds_read_b64_tr_b16 a[66:67], v2 offset:18432
    ds_read_b64_tr_b16 a[68:69], v3 offset:16384
    ds_read_b64_tr_b16 a[70:71], v3 offset:18432
    ds_read_b64_tr_b16 a[72:73], v4 offset:16384
    ds_read_b64_tr_b16 a[74:75], v4 offset:18432
    ds_read_b64_tr_b16 a[76:77], v5 offset:16384
    ds_read_b64_tr_b16 a[78:79], v5 offset:18432
    s_waitcnt vmcnt(32)
    ds_read_b64_tr_b16 a[80:81], v2 offset:20480
    ds_read_b64_tr_b16 a[82:83], v2 offset:22528
    ds_read_b64_tr_b16 a[84:85], v3 offset:20480
    ds_read_b64_tr_b16 a[86:87], v3 offset:22528
    ds_read_b64_tr_b16 a[88:89], v4 offset:20480
    ds_read_b64_tr_b16 a[90:91], v4 offset:22528
    ds_read_b64_tr_b16 a[92:93], v5 offset:20480
    ds_read_b64_tr_b16 a[94:95], v5 offset:22528
    s_waitcnt lgkmcnt(0)
    s_waitcnt vmcnt(28)
    ds_read_b64_tr_b16 a[96:97], v2 offset:24576
    ds_read_b64_tr_b16 a[98:99], v2 offset:26624
    ds_read_b64_tr_b16 a[100:101], v3 offset:24576
    ds_read_b64_tr_b16 a[102:103], v3 offset:26624
    ds_read_b64_tr_b16 a[104:105], v4 offset:24576
    ds_read_b64_tr_b16 a[106:107], v4 offset:26624
    ds_read_b64_tr_b16 a[108:109], v5 offset:24576
    ds_read_b64_tr_b16 a[110:111], v5 offset:26624
    s_waitcnt vmcnt(24)
    ds_read_b64_tr_b16 a[112:113], v2 offset:28672
    ds_read_b64_tr_b16 a[114:115], v2 offset:30720
    ds_read_b64_tr_b16 a[116:117], v3 offset:28672
    ds_read_b64_tr_b16 a[118:119], v3 offset:30720
    ds_read_b64_tr_b16 a[120:121], v4 offset:28672
    ds_read_b64_tr_b16 a[122:123], v4 offset:30720
    ds_read_b64_tr_b16 a[124:125], v5 offset:28672
    ds_read_b64_tr_b16 a[126:127], v5 offset:30720
    s_waitcnt lgkmcnt(0)
    s_waitcnt vmcnt(20)
    ds_read_b64_tr_b16 a[128:129], v196 offset:0
    ds_read_b64_tr_b16 a[130:131], v196 offset:2048
    ds_read_b64_tr_b16 a[132:133], v197 offset:0
    ds_read_b64_tr_b16 a[134:135], v197 offset:2048
    ds_read_b64_tr_b16 a[136:137], v198 offset:0
    ds_read_b64_tr_b16 a[138:139], v198 offset:2048
    ds_read_b64_tr_b16 a[140:141], v199 offset:0
    ds_read_b64_tr_b16 a[142:143], v199 offset:2048
    s_waitcnt vmcnt(16)
    ds_read_b64_tr_b16 a[144:145], v196 offset:4096
    ds_read_b64_tr_b16 a[146:147], v196 offset:6144
    ds_read_b64_tr_b16 a[148:149], v197 offset:4096
    ds_read_b64_tr_b16 a[150:151], v197 offset:6144
    ds_read_b64_tr_b16 a[152:153], v198 offset:4096
    ds_read_b64_tr_b16 a[154:155], v198 offset:6144
    ds_read_b64_tr_b16 a[156:157], v199 offset:4096
    ds_read_b64_tr_b16 a[158:159], v199 offset:6144
    s_waitcnt lgkmcnt(0)
    s_branch L_pre2
L_ep1_1:
    s_cmp_lg_u32 s60, 1
    s_cbranch_scc1 L_ep1_2
    s_waitcnt vmcnt(13)
    s_waitcnt vmcnt(8)
    v_mfma_f32_16x16x32_bf16 v[16:19], a[224:227], v[136:139], v[16:19]
    s_add_u32 m0, s78, 4096
    s_add_u32 s72, s75, 1
    s_cmp_ge_u32 s72, 14
    s_cselect_b32 s71, 14, 0
    s_sub_u32 s72, s72, s71
    s_mul_i32 s72, s72, 131072
    s_add_u32 s71, s72, s3
    v_mfma_f32_16x16x32_bf16 v[36:39], a[228:231], v[136:139], v[36:39]
    buffer_load_dwordx4 v220, s[28:31], s71 offen offset:0  lds
    v_mfma_f32_16x16x32_bf16 v[16:19], a[240:243], v[96:99], v[16:19]
    buffer_load_dwordx4 v221, s[28:31], s71 offen offset:1024  lds
    v_mfma_f32_16x16x32_bf16 v[36:39], a[244:247], v[96:99], v[36:39]
    buffer_load_dwordx4 v222, s[28:31], s71 offen offset:2048  lds
    s_waitcnt vmcnt(10)
    v_mfma_f32_16x16x32_bf16 v[20:23], a[224:227], v[140:143], v[20:23]
    buffer_load_dwordx4 v223, s[28:31], s71 offen offset:3072  lds
    v_mfma_f32_16x16x32_bf16 v[40:43], a[228:231], v[140:143], v[40:43]
    s_add_u32 m0, s78, 8192
    s_add_u32 s72, s75, 2
    s_cmp_ge_u32 s72, 14
    s_cselect_b32 s71, 14, 0
    s_sub_u32 s72, s72, s71
    s_mul_i32 s72, s72, 131072
    s_add_u32 s71, s72, s3
    v_mfma_f32_16x16x32_bf16 v[20:23], a[240:243], v[100:103], v[20:23]
    buffer_load_dwordx4 v220, s[28:31], s71 offen offset:0  lds
    v_mfma_f32_16x16x32_bf16 v[40:43], a[244:247], v[100:103], v[40:43]
    ds_write_b128 v200, v[16:19] offset:57344
    s_waitcnt vmcnt(11)
    v_mfma_f32_16x16x32_bf16 v[24:27], a[224:227], v[144:147], v[24:27]
    ds_write_b128 v200, v[36:39] offset:58368
    v_mfma_f32_16x16x32_bf16 v[44:47], a[228:231], v[144:147], v[44:47]
    buffer_load_dwordx4 v221, s[28:31], s71 offen offset:1024  lds
    v_mfma_f32_16x16x32_bf16 v[24:27], a[240:243], v[104:107], v[24:27]
    buffer_load_dwordx4 v222, s[28:31], s71 offen offset:2048  lds
    v_mfma_f32_16x16x32_bf16 v[44:47], a[244:247], v[104:107], v[44:47]
    ds_write_b128 v200, v[20:23] offset:59392
    s_waitcnt vmcnt(12)
    v_mfma_f32_16x16x32_bf16 v[28:31], a[224:227], v[148:151], v[28:31]
    ds_write_b128 v200, v[40:43] offset:60416
    v_mfma_f32_16x16x32_bf16 v[48:51], a[228:231], v[148:151], v[48:51]
    buffer_load_dwordx4 v223, s[28:31], s71 offen offset:3072  lds
    v_mfma_f32_16x16x32_bf16 v[28:31], a[240:243], v[108:111], v[28:31]
    v_mfma_f32_16x16x32_bf16 v[48:51], a[244:247], v[108:111], v[48:51]
    ds_write_b128 v200, v[24:27] offset:61440
    v_mfma_f32_16x16x32_bf16 v[68:71], a[232:235], v[148:151], v[68:71]
    ds_write_b128 v200, v[44:47] offset:62464
    v_mfma_f32_16x16x32_bf16 v[88:91], a[236:239], v[148:151], v[88:91]
    v_mfma_f32_16x16x32_bf16 v[68:71], a[248:251], v[108:111], v[68:71]
    v_mfma_f32_16x16x32_bf16 v[88:91], a[252:255], v[108:111], v[88:91]
    s_waitcnt vmcnt(11)
    v_mfma_f32_16x16x32_bf16 v[32:35], a[224:227], v[152:155], v[32:35]
    v_mfma_f32_16x16x32_bf16 v[52:55], a[228:231], v[152:155], v[52:55]
    ds_write_b128 v200, v[28:31] offset:63488
    v_mfma_f32_16x16x32_bf16 v[32:35], a[240:243], v[112:115], v[32:35]
    ds_write_b128 v200, v[48:51] offset:64512
    v_mfma_f32_16x16x32_bf16 v[52:55], a[244:247], v[112:115], v[52:55]
    v_mfma_f32_16x16x32_bf16 v[72:75], a[232:235], v[152:155], v[72:75]
    v_mfma_f32_16x16x32_bf16 v[92:95], a[236:239], v[152:155], v[92:95]
    ds_write_b128 v202, v[68:71] offset:10240
    v_mfma_f32_16x16x32_bf16 v[72:75], a[248:251], v[112:115], v[72:75]
    ds_write_b128 v202, v[88:91] offset:11264
    v_mfma_f32_16x16x32_bf16 v[92:95], a[252:255], v[112:115], v[92:95]
    v_mfma_f32_16x16x32_bf16 v[56:59], a[232:235], v[136:139], v[56:59]
    ds_write_b128 v202, v[32:35] offset:8192
    v_mfma_f32_16x16x32_bf16 v[76:79], a[236:239], v[136:139], v[76:79]
    ds_write_b128 v202, v[52:55] offset:9216
    v_mfma_f32_16x16x32_bf16 v[56:59], a[248:251], v[96:99], v[56:59]
    v_mfma_f32_16x16x32_bf16 v[76:79], a[252:255], v[96:99], v[76:79]
    v_mfma_f32_16x16x32_bf16 v[60:63], a[232:235], v[140:143], v[60:63]
    ds_write_b128 v202, v[72:75] offset:12288
    v_mfma_f32_16x16x32_bf16 v[80:83], a[236:239], v[140:143], v[80:83]
    ds_write_b128 v202, v[92:95] offset:13312
    v_mfma_f32_16x16x32_bf16 v[60:63], a[248:251], v[100:103], v[60:63]
    v_mfma_f32_16x16x32_bf16 v[80:83], a[252:255], v[100:103], v[80:83]
    v_mfma_f32_16x16x32_bf16 v[64:67], a[232:235], v[144:147], v[64:67]
    v_mfma_f32_16x16x32_bf16 v[84:87], a[236:239], v[144:147], v[84:87]
    v_mfma_f32_16x16x32_bf16 v[64:67], a[248:251], v[104:107], v[64:67]
    v_mfma_f32_16x16x32_bf16 v[84:87], a[252:255], v[104:107], v[84:87]
    s_add_u32 m0, s78, 12288
    s_add_u32 s72, s75, 3
    s_cmp_ge_u32 s72, 14
    s_cselect_b32 s77, 14, 0
    s_sub_u32 s72, s72, s77
    s_mul_i32 s72, s72, 131072
    s_add_u32 s77, s72, s3
    buffer_load_dwordx4 v220, s[28:31], s77 offen offset:0  lds
    buffer_load_dwordx4 v221, s[28:31], s77 offen offset:1024  lds
    buffer_load_dwordx4 v222, s[28:31], s77 offen offset:2048  lds
    buffer_load_dwordx4 v223, s[28:31], s77 offen offset:3072  lds
    s_waitcnt lgkmcnt(0)
    s_barrier
    ds_read_b128 v[96:99], v200 offset:28672
    ds_read_b128 v[100:103], v200 offset:29696
    ds_read_b128 v[104:107], v201 offset:30720
    ds_read_b128 v[108:111], v201 offset:31744
    ds_read_b128 v[112:115], v202 offset:26624
    ds_read_b128 v[116:119], v202 offset:27648
    ds_read_b128 v[120:123], v200 offset:30720
    ds_read_b128 v[124:127], v200 offset:31744
    ds_read_b128 v[128:131], v202 offset:16384
    ds_read_b128 v[132:135], v202 offset:17408
    ds_read_b128 v[136:139], v202 offset:28672
    ds_read_b128 v[140:143], v202 offset:29696
    ds_read_b128 v[144:147], v202 offset:0
    ds_read_b128 v[148:151], v202 offset:1024
    ds_read_b128 v[152:155], v202 offset:18432
    ds_read_b128 v[156:159], v202 offset:19456
    ds_read_b128 v[160:163], v202 offset:30720
    ds_read_b128 v[164:167], v202 offset:31744
    v_lshlrev_b32 v206, 16, v10
    v_and_b32 v207, 0xffff0000, v10
    v_lshlrev_b32 v208, 16, v11
    v_and_b32 v209, 0xffff0000, v11
    v_lshlrev_b32 v210, 16, v12
    v_and_b32 v211, 0xffff0000, v12
    v_lshlrev_b32 v212, 16, v13
    v_and_b32 v213, 0xffff0000, v13
    v_pk_add_f32 v[56:57], v[56:57], v[206:207]
    v_pk_add_f32 v[58:59], v[58:59], v[208:209]
    v_pk_add_f32 v[76:77], v[76:77], v[210:211]
    v_pk_add_f32 v[78:79], v[78:79], v[212:213]
    v_pk_add_f32 v[60:61], v[60:61], v[206:207]
    v_pk_add_f32 v[62:63], v[62:63], v[208:209]
    v_pk_add_f32 v[80:81], v[80:81], v[210:211]
    v_pk_add_f32 v[82:83], v[82:83], v[212:213]
    v_pk_add_f32 v[64:65], v[64:65], v[206:207]
    v_pk_add_f32 v[66:67], v[66:67], v[208:209]
    v_pk_add_f32 v[84:85], v[84:85], v[210:211]
    v_pk_add_f32 v[86:87], v[86:87], v[212:213]
    s_waitcnt lgkmcnt(15)
    v_pk_add_f32 v[56:57], v[56:57], v[96:97]
    v_pk_add_f32 v[58:59], v[58:59], v[98:99]
    s_waitcnt lgkmcnt(15)
    v_pk_add_f32 v[76:77], v[76:77], v[100:101]
    v_pk_add_f32 v[78:79], v[78:79], v[102:103]
    s_waitcnt lgkmcnt(15)
    v_pk_add_f32 v[56:57], v[56:57], v[104:105]
    v_pk_add_f32 v[58:59], v[58:59], v[106:107]
    s_waitcnt lgkmcnt(14)
    v_pk_add_f32 v[76:77], v[76:77], v[108:109]
    v_pk_add_f32 v[78:79], v[78:79], v[110:111]
    s_waitcnt lgkmcnt(13)
    v_pk_add_f32 v[56:57], v[56:57], v[112:113]
    v_pk_add_f32 v[58:59], v[58:59], v[114:115]
    s_waitcnt lgkmcnt(12)
    v_pk_add_f32 v[76:77], v[76:77], v[116:117]
    v_pk_add_f32 v[78:79], v[78:79], v[118:119]
    s_waitcnt lgkmcnt(11)
    v_pk_add_f32 v[60:61], v[60:61], v[120:121]
    v_pk_add_f32 v[62:63], v[62:63], v[122:123]
    s_waitcnt lgkmcnt(10)
    v_pk_add_f32 v[80:81], v[80:81], v[124:125]
    v_pk_add_f32 v[82:83], v[82:83], v[126:127]
    s_waitcnt lgkmcnt(9)
    v_pk_add_f32 v[60:61], v[60:61], v[128:129]
    v_pk_add_f32 v[62:63], v[62:63], v[130:131]
    s_waitcnt lgkmcnt(8)
    v_pk_add_f32 v[80:81], v[80:81], v[132:133]
    v_pk_add_f32 v[82:83], v[82:83], v[134:135]
    s_waitcnt lgkmcnt(7)
    v_pk_add_f32 v[60:61], v[60:61], v[136:137]
    v_pk_add_f32 v[62:63], v[62:63], v[138:139]
    s_waitcnt lgkmcnt(6)
    v_pk_add_f32 v[80:81], v[80:81], v[140:141]
    v_pk_add_f32 v[82:83], v[82:83], v[142:143]
    s_waitcnt lgkmcnt(5)
    v_pk_add_f32 v[64:65], v[64:65], v[144:145]
    v_pk_add_f32 v[66:67], v[66:67], v[146:147]
    s_waitcnt lgkmcnt(4)
    v_pk_add_f32 v[84:85], v[84:85], v[148:149]
    v_pk_add_f32 v[86:87], v[86:87], v[150:151]
    s_waitcnt lgkmcnt(3)
    v_pk_add_f32 v[64:65], v[64:65], v[152:153]
    v_pk_add_f32 v[66:67], v[66:67], v[154:155]
    s_waitcnt lgkmcnt(2)
    v_pk_add_f32 v[84:85], v[84:85], v[156:157]
    v_pk_add_f32 v[86:87], v[86:87], v[158:159]
    s_waitcnt lgkmcnt(1)
    v_pk_add_f32 v[64:65], v[64:65], v[160:161]
    v_pk_add_f32 v[66:67], v[66:67], v[162:163]
    s_waitcnt lgkmcnt(0)
    v_pk_add_f32 v[84:85], v[84:85], v[164:165]
    v_pk_add_f32 v[86:87], v[86:87], v[166:167]
    s_barrier
    v_pk_mul_f32 v[96:97], v[56:57], v[56:57]
    v_pk_mul_f32 v[98:99], v[58:59], v[58:59]
    v_pk_mul_f32 v[100:101], v[76:77], v[76:77]
    v_pk_mul_f32 v[102:103], v[78:79], v[78:79]
    v_pk_mul_f32 v[104:105], v[60:61], v[60:61]
    v_pk_mul_f32 v[106:107], v[62:63], v[62:63]
    v_pk_mul_f32 v[108:109], v[80:81], v[80:81]
    v_pk_mul_f32 v[110:111], v[82:83], v[82:83]
    v_pk_mul_f32 v[112:113], v[64:65], v[64:65]
    v_pk_mul_f32 v[114:115], v[66:67], v[66:67]
    v_pk_mul_f32 v[116:117], v[84:85], v[84:85]
    v_pk_mul_f32 v[118:119], v[86:87], v[86:87]
    v_pk_fma_f32 v[96:97], v[96:97], s[100:101], v[204:205]
    v_pk_fma_f32 v[98:99], v[98:99], s[100:101], v[204:205]
    v_pk_fma_f32 v[100:101], v[100:101], s[100:101], v[204:205]
    v_pk_fma_f32 v[102:103], v[102:103], s[100:101], v[204:205]
    v_pk_fma_f32 v[104:105], v[104:105], s[100:101], v[204:205]
    v_pk_fma_f32 v[106:107], v[106:107], s[100:101], v[204:205]
    v_pk_fma_f32 v[108:109], v[108:109], s[100:101], v[204:205]
    v_pk_fma_f32 v[110:111], v[110:111], s[100:101], v[204:205]
    v_pk_fma_f32 v[112:113], v[112:113], s[100:101], v[204:205]
    v_pk_fma_f32 v[114:115], v[114:115], s[100:101], v[204:205]
    v_pk_fma_f32 v[116:117], v[116:117], s[100:101], v[204:205]
    v_pk_fma_f32 v[118:119], v[118:119], s[100:101], v[204:205]
    v_pk_mul_f32 v[96:97], v[96:97], v[56:57]
    v_pk_mul_f32 v[98:99], v[98:99], v[58:59]
    v_pk_mul_f32 v[100:101], v[100:101], v[76:77]
    v_pk_mul_f32 v[102:103], v[102:103], v[78:79]
    v_pk_mul_f32 v[104:105], v[104:105], v[60:61]
    v_pk_mul_f32 v[106:107], v[106:107], v[62:63]
    v_pk_mul_f32 v[108:109], v[108:109], v[80:81]
    v_pk_mul_f32 v[110:111], v[110:111], v[82:83]
    v_pk_mul_f32 v[112:113], v[112:113], v[64:65]
    v_pk_mul_f32 v[114:115], v[114:115], v[66:67]
    v_pk_mul_f32 v[116:117], v[116:117], v[84:85]
    v_pk_mul_f32 v[118:119], v[118:119], v[86:87]
    v_exp_f32 v96, v96
    v_exp_f32 v97, v97
    v_exp_f32 v98, v98
    v_exp_f32 v99, v99
    v_exp_f32 v100, v100
    v_exp_f32 v101, v101
    v_exp_f32 v102, v102
    v_exp_f32 v103, v103
    v_exp_f32 v104, v104
    v_exp_f32 v105, v105
    v_exp_f32 v106, v106
    v_exp_f32 v107, v107
    v_exp_f32 v108, v108
    v_exp_f32 v109, v109
    v_exp_f32 v110, v110
    v_exp_f32 v111, v111
    v_exp_f32 v112, v112
    v_exp_f32 v113, v113
    v_exp_f32 v114, v114
    v_exp_f32 v115, v115
    v_exp_f32 v116, v116
    v_exp_f32 v117, v117
    v_exp_f32 v118, v118
    v_exp_f32 v119, v119
    v_pk_add_f32 v[96:97], v[96:97], 1.0 op_sel_hi:[1,0]
    v_pk_add_f32 v[98:99], v[98:99], 1.0 op_sel_hi:[1,0]
    v_pk_add_f32 v[100:101], v[100:101], 1.0 op_sel_hi:[1,0]
    v_pk_add_f32 v[102:103], v[102:103], 1.0 op_sel_hi:[1,0]
    v_pk_add_f32 v[104:105], v[104:105], 1.0 op_sel_hi:[1,0]
    v_pk_add_f32 v[106:107], v[106:107], 1.0 op_sel_hi:[1,0]
    v_pk_add_f32 v[108:109], v[108:109], 1.0 op_sel_hi:[1,0]
    v_pk_add_f32 v[110:111], v[110:111], 1.0 op_sel_hi:[1,0]
    v_pk_add_f32 v[112:113], v[112:113], 1.0 op_sel_hi:[1,0]
    v_pk_add_f32 v[114:115], v[114:115], 1.0 op_sel_hi:[1,0]
    v_pk_add_f32 v[116:117], v[116:117], 1.0 op_sel_hi:[1,0]
    v_pk_add_f32 v[118:119], v[118:119], 1.0 op_sel_hi:[1,0]
    v_rcp_f32 v96, v96
    v_rcp_f32 v97, v97
    v_rcp_f32 v98, v98
    v_rcp_f32 v99, v99
    v_rcp_f32 v100, v100
    v_rcp_f32 v101, v101
    v_rcp_f32 v102, v102
    v_rcp_f32 v103, v103
    v_rcp_f32 v104, v104
    v_rcp_f32 v105, v105
    v_rcp_f32 v106, v106
    v_rcp_f32 v107, v107
    v_rcp_f32 v108, v108
    v_rcp_f32 v109, v109
    v_rcp_f32 v110, v110
    v_rcp_f32 v111, v111
    v_rcp_f32 v112, v112
    v_rcp_f32 v113, v113
    v_rcp_f32 v114, v114
    v_rcp_f32 v115, v115
    v_rcp_f32 v116, v116
    v_rcp_f32 v117, v117
    v_rcp_f32 v118, v118
    v_rcp_f32 v119, v119
    s_nop 0
    v_pk_mul_f32 v[56:57], v[56:57], v[96:97]
    v_pk_mul_f32 v[58:59], v[58:59], v[98:99]
    v_pk_mul_f32 v[76:77], v[76:77], v[100:101]
    v_pk_mul_f32 v[78:79], v[78:79], v[102:103]
    v_pk_mul_f32 v[60:61], v[60:61], v[104:105]
    v_pk_mul_f32 v[62:63], v[62:63], v[106:107]
    v_pk_mul_f32 v[80:81], v[80:81], v[108:109]
    v_pk_mul_f32 v[82:83], v[82:83], v[110:111]
    v_pk_mul_f32 v[64:65], v[64:65], v[112:113]
    v_pk_mul_f32 v[66:67], v[66:67], v[114:115]
    v_pk_mul_f32 v[84:85], v[84:85], v[116:117]
    v_pk_mul_f32 v[86:87], v[86:87], v[118:119]
    s_lshl_b32 s68, s63, 1
    s_add_u32 s68, s68, 1
    s_mul_i32 s68, s68, 40960
    s_mul_i32 s69, s64, 5120
    s_add_u32 s68, s68, s69
    v_cvt_pk_bf16_f32 v160, v56, v57
    v_cvt_pk_bf16_f32 v161, v58, v59
    v_cvt_pk_bf16_f32 v162, v76, v77
    v_cvt_pk_bf16_f32 v163, v78, v79
    s_add_u32 s69, s68, 0
    buffer_store_dwordx4 v[160:163], v200, s[36:39], s69 offen sc1
    v_cvt_pk_bf16_f32 v164, v60, v61
    v_cvt_pk_bf16_f32 v165, v62, v63
    v_cvt_pk_bf16_f32 v166, v80, v81
    v_cvt_pk_bf16_f32 v167, v82, v83
    s_add_u32 s69, s68, 1024
    buffer_store_dwordx4 v[164:167], v200, s[36:39], s69 offen sc1
    v_cvt_pk_bf16_f32 v168, v64, v65
    v_cvt_pk_bf16_f32 v169, v66, v67
    v_cvt_pk_bf16_f32 v170, v84, v85
    v_cvt_pk_bf16_f32 v171, v86, v87
    s_add_u32 s69, s68, 2048
    buffer_store_dwordx4 v[168:171], v200, s[36:39], s69 offen sc1
    s_add_u32 m0, s78, 16384
    s_add_u32 s72, s75, 4
    s_cmp_ge_u32 s72, 14
    s_cselect_b32 s77, 14, 0
    s_sub_u32 s72, s72, s77
    s_mul_i32 s72, s72, 131072
    s_add_u32 s77, s72, s3
    buffer_load_dwordx4 v220, s[28:31], s77 offen offset:0  lds
    buffer_load_dwordx4 v221, s[28:31], s77 offen offset:1024  lds
    buffer_load_dwordx4 v222, s[28:31], s77 offen offset:2048  lds
    buffer_load_dwordx4 v223, s[28:31], s77 offen offset:3072  lds
    s_add_u32 m0, s78, 20480
    s_add_u32 s72, s75, 5
    s_cmp_ge_u32 s72, 14
    s_cselect_b32 s77, 14, 0
    s_sub_u32 s72, s72, s77
    s_mul_i32 s72, s72, 131072
    s_add_u32 s77, s72, s3
    buffer_load_dwordx4 v220, s[28:31], s77 offen offset:0  lds
    buffer_load_dwordx4 v221, s[28:31], s77 offen offset:1024  lds
    buffer_load_dwordx4 v222, s[28:31], s77 offen offset:2048  lds
    buffer_load_dwordx4 v223, s[28:31], s77 offen offset:3072  lds
    s_waitcnt vmcnt(11)
    ds_read_b64_tr_b16 a[0:1], v2 offset:0
    ds_read_b64_tr_b16 a[2:3], v2 offset:2048
    ds_read_b64_tr_b16 a[4:5], v3 offset:0
    ds_read_b64_tr_b16 a[6:7], v3 offset:2048
    ds_read_b64_tr_b16 a[8:9], v4 offset:0
    ds_read_b64_tr_b16 a[10:11], v4 offset:2048
    ds_read_b64_tr_b16 a[12:13], v5 offset:0
    ds_read_b64_tr_b16 a[14:15], v5 offset:2048
    ds_read_b64_tr_b16 a[16:17], v2 offset:4096
    ds_read_b64_tr_b16 a[18:19], v2 offset:6144
    ds_read_b64_tr_b16 a[20:21], v3 offset:4096
    ds_read_b64_tr_b16 a[22:23], v3 offset:6144
    ds_read_b64_tr_b16 a[24:25], v4 offset:4096
    ds_read_b64_tr_b16 a[26:27], v4 offset:6144
    ds_read_b64_tr_b16 a[28:29], v5 offset:4096
    ds_read_b64_tr_b16 a[30:31], v5 offset:6144
    s_waitcnt lgkmcnt(0)
    ds_read_b64_tr_b16 a[32:33], v2 offset:8192
    ds_read_b64_tr_b16 a[34:35], v2 offset:10240
    ds_read_b64_tr_b16 a[36:37], v3 offset:8192
    ds_read_b64_tr_b16 a[38:39], v3 offset:10240
    ds_read_b64_tr_b16 a[40:41], v4 offset:8192
    ds_read_b64_tr_b16 a[42:43], v4 offset:10240
    ds_read_b64_tr_b16 a[44:45], v5 offset:8192
    ds_read_b64_tr_b16 a[46:47], v5 offset:10240
    ds_read_b64_tr_b16 a[48:49], v2 offset:12288
    ds_read_b64_tr_b16 a[50:51], v2 offset:14336
    ds_read_b64_tr_b16 a[52:53], v3 offset:12288
    ds_read_b64_tr_b16 a[54:55], v3 offset:14336
    ds_read_b64_tr_b16 a[56:57], v4 offset:12288
    ds_read_b64_tr_b16 a[58:59], v4 offset:14336
    ds_read_b64_tr_b16 a[60:61], v5 offset:12288
    ds_read_b64_tr_b16 a[62:63], v5 offset:14336
    s_waitcnt lgkmcnt(0)
    s_waitcnt vmcnt(8)
    s_barrier
    s_add_u32 m0, s78, 24576
    s_add_u32 s72, s75, 6
    s_cmp_ge_u32 s72, 14
    s_cselect_b32 s77, 14, 0
    s_sub_u32 s72, s72, s77
    s_mul_i32 s72, s72, 131072
    s_add_u32 s77, s72, s3
    buffer_load_dwordx4 v220, s[28:31], s77 offen offset:0  lds
    buffer_load_dwordx4 v221, s[28:31], s77 offen offset:1024  lds
    buffer_load_dwordx4 v222, s[28:31], s77 offen offset:2048  lds
    buffer_load_dwordx4 v223, s[28:31], s77 offen offset:3072  lds
    s_add_u32 m0, s78, 28672
    s_add_u32 s72, s75, 7
    s_cmp_ge_u32 s72, 14
    s_cselect_b32 s77, 14, 0
    s_sub_u32 s72, s72, s77
    s_mul_i32 s72, s72, 131072
    s_add_u32 s77, s72, s3
    buffer_load_dwordx4 v220, s[28:31], s77 offen offset:0  lds
    buffer_load_dwordx4 v221, s[28:31], s77 offen offset:1024  lds
    buffer_load_dwordx4 v222, s[28:31], s77 offen offset:2048  lds
    buffer_load_dwordx4 v223, s[28:31], s77 offen offset:3072  lds
    s_add_u32 m0, s99, 0
    s_add_u32 s72, s75, 8
    s_cmp_ge_u32 s72, 14
    s_cselect_b32 s77, 14, 0
    s_sub_u32 s72, s72, s77
    s_mul_i32 s72, s72, 131072
    s_add_u32 s77, s72, s3
    buffer_load_dwordx4 v220, s[28:31], s77 offen offset:0  lds
    buffer_load_dwordx4 v221, s[28:31], s77 offen offset:1024  lds
    buffer_load_dwordx4 v222, s[28:31], s77 offen offset:2048  lds
    buffer_load_dwordx4 v223, s[28:31], s77 offen offset:3072  lds
    s_add_u32 m0, s99, 4096
    s_add_u32 s72, s75, 9
    s_cmp_ge_u32 s72, 14
    s_cselect_b32 s77, 14, 0
    s_sub_u32 s72, s72, s77
    s_mul_i32 s72, s72, 131072
    s_add_u32 s77, s72, s3
    buffer_load_dwordx4 v220, s[28:31], s77 offen offset:0  lds
    buffer_load_dwordx4 v221, s[28:31], s77 offen offset:1024  lds
    buffer_load_dwordx4 v222, s[28:31], s77 offen offset:2048  lds
    buffer_load_dwordx4 v223, s[28:31], s77 offen offset:3072  lds
    s_add_u32 m0, s78, 0
    s_add_u32 s72, s75, 10
    s_cmp_ge_u32 s72, 14
    s_cselect_b32 s77, 14, 0
    s_sub_u32 s72, s72, s77
    s_mul_i32 s72, s72, 131072
    s_add_u32 s77, s72, s3
    buffer_load_dwordx4 v220, s[28:31], s77 offen offset:0  lds
    buffer_load_dwordx4 v221, s[28:31], s77 offen offset:1024  lds
    buffer_load_dwordx4 v222, s[28:31], s77 offen offset:2048  lds
    buffer_load_dwordx4 v223, s[28:31], s77 offen offset:3072  lds
    s_add_u32 m0, s78, 4096
    s_add_u32 s72, s75, 11
    s_cmp_ge_u32 s72, 14
    s_cselect_b32 s77, 14, 0
    s_sub_u32 s72, s72, s77
    s_mul_i32 s72, s72, 131072
    s_add_u32 s77, s72, s3
    buffer_load_dwordx4 v220, s[28:31], s77 offen offset:0  lds
    buffer_load_dwordx4 v221, s[28:31], s77 offen offset:1024  lds
    buffer_load_dwordx4 v222, s[28:31], s77 offen offset:2048  lds
    buffer_load_dwordx4 v223, s[28:31], s77 offen offset:3072  lds
    s_add_u32 m0, s78, 8192
    s_add_u32 s72, s75, 12
    s_cmp_ge_u32 s72, 14
    s_cselect_b32 s77, 14, 0
    s_sub_u32 s72, s72, s77
    s_mul_i32 s72, s72, 131072
    s_add_u32 s77, s72, s3
    buffer_load_dwordx4 v220, s[28:31], s77 offen offset:0  lds
    buffer_load_dwordx4 v221, s[28:31], s77 offen offset:1024  lds
    buffer_load_dwordx4 v222, s[28:31], s77 offen offset:2048  lds
    buffer_load_dwordx4 v223, s[28:31], s77 offen offset:3072  lds
    s_add_u32 m0, s78, 12288
    s_add_u32 s72, s75, 13
    s_cmp_ge_u32 s72, 14
    s_cselect_b32 s77, 14, 0
    s_sub_u32 s72, s72, s77
    s_mul_i32 s72, s72, 131072
    s_add_u32 s77, s72, s3
    buffer_load_dwordx4 v220, s[28:31], s77 offen offset:0  lds
    buffer_load_dwordx4 v221, s[28:31], s77 offen offset:1024  lds
    buffer_load_dwordx4 v222, s[28:31], s77 offen offset:2048  lds
    buffer_load_dwordx4 v223, s[28:31], s77 offen offset:3072  lds
    s_waitcnt vmcnt(36)
    ds_read_b64_tr_b16 a[64:65], v2 offset:16384
    ds_read_b64_tr_b16 a[66:67], v2 offset:18432
    ds_read_b64_tr_b16 a[68:69], v3 offset:16384
    ds_read_b64_tr_b16 a[70:71], v3 offset:18432
    ds_read_b64_tr_b16 a[72:73], v4 offset:16384
    ds_read_b64_tr_b16 a[74:75], v4 offset:18432
    ds_read_b64_tr_b16 a[76:77], v5 offset:16384
    ds_read_b64_tr_b16 a[78:79], v5 offset:18432
    s_waitcnt vmcnt(32)
    ds_read_b64_tr_b16 a[80:81], v2 offset:20480
    ds_read_b64_tr_b16 a[82:83], v2 offset:22528
    ds_read_b64_tr_b16 a[84:85], v3 offset:20480
    ds_read_b64_tr_b16 a[86:87], v3 offset:22528
    ds_read_b64_tr_b16 a[88:89], v4 offset:20480
    ds_read_b64_tr_b16 a[90:91], v4 offset:22528
    ds_read_b64_tr_b16 a[92:93], v5 offset:20480
    ds_read_b64_tr_b16 a[94:95], v5 offset:22528
    s_waitcnt lgkmcnt(0)
    s_waitcnt vmcnt(28)
    ds_read_b64_tr_b16 a[96:97], v2 offset:24576
    ds_read_b64_tr_b16 a[98:99], v2 offset:26624
    ds_read_b64_tr_b16 a[100:101], v3 offset:24576
    ds_read_b64_tr_b16 a[102:103], v3 offset:26624
    ds_read_b64_tr_b16 a[104:105], v4 offset:24576
    ds_read_b64_tr_b16 a[106:107], v4 offset:26624
    ds_read_b64_tr_b16 a[108:109], v5 offset:24576
    ds_read_b64_tr_b16 a[110:111], v5 offset:26624
    s_waitcnt vmcnt(24)
    ds_read_b64_tr_b16 a[112:113], v2 offset:28672
    ds_read_b64_tr_b16 a[114:115], v2 offset:30720
    ds_read_b64_tr_b16 a[116:117], v3 offset:28672
    ds_read_b64_tr_b16 a[118:119], v3 offset:30720
    ds_read_b64_tr_b16 a[120:121], v4 offset:28672
    ds_read_b64_tr_b16 a[122:123], v4 offset:30720
    ds_read_b64_tr_b16 a[124:125], v5 offset:28672
    ds_read_b64_tr_b16 a[126:127], v5 offset:30720
    s_waitcnt lgkmcnt(0)
    s_waitcnt vmcnt(20)
    ds_read_b64_tr_b16 a[128:129], v196 offset:0
    ds_read_b64_tr_b16 a[130:131], v196 offset:2048
    ds_read_b64_tr_b16 a[132:133], v197 offset:0
    ds_read_b64_tr_b16 a[134:135], v197 offset:2048
    ds_read_b64_tr_b16 a[136:137], v198 offset:0
    ds_read_b64_tr_b16 a[138:139], v198 offset:2048
    ds_read_b64_tr_b16 a[140:141], v199 offset:0
    ds_read_b64_tr_b16 a[142:143], v199 offset:2048
    s_waitcnt vmcnt(16)
    ds_read_b64_tr_b16 a[144:145], v196 offset:4096
    ds_read_b64_tr_b16 a[146:147], v196 offset:6144
    ds_read_b64_tr_b16 a[148:149], v197 offset:4096
    ds_read_b64_tr_b16 a[150:151], v197 offset:6144
    ds_read_b64_tr_b16 a[152:153], v198 offset:4096
    ds_read_b64_tr_b16 a[154:155], v198 offset:6144
    ds_read_b64_tr_b16 a[156:157], v199 offset:4096
    ds_read_b64_tr_b16 a[158:159], v199 offset:6144
    s_waitcnt lgkmcnt(0)
    s_branch L_pre2
L_ep1_2:
    s_cmp_lg_u32 s60, 2
    s_cbranch_scc1 L_ep1_3
    s_waitcnt vmcnt(13)
    s_waitcnt vmcnt(8)
    v_mfma_f32_16x16x32_bf16 v[16:19], a[224:227], v[136:139], v[16:19]
    s_add_u32 m0, s78, 4096
    s_add_u32 s72, s75, 1
    s_cmp_ge_u32 s72, 14
    s_cselect_b32 s71, 14, 0
    s_sub_u32 s72, s72, s71
    s_mul_i32 s72, s72, 131072
    s_add_u32 s71, s72, s3
    v_mfma_f32_16x16x32_bf16 v[36:39], a[228:231], v[136:139], v[36:39]
    buffer_load_dwordx4 v220, s[28:31], s71 offen offset:0  lds
    v_mfma_f32_16x16x32_bf16 v[16:19], a[240:243], v[96:99], v[16:19]
    buffer_load_dwordx4 v221, s[28:31], s71 offen offset:1024  lds
    v_mfma_f32_16x16x32_bf16 v[36:39], a[244:247], v[96:99], v[36:39]
    buffer_load_dwordx4 v222, s[28:31], s71 offen offset:2048  lds
    v_mfma_f32_16x16x32_bf16 v[56:59], a[232:235], v[136:139], v[56:59]
    buffer_load_dwordx4 v223, s[28:31], s71 offen offset:3072  lds
    v_mfma_f32_16x16x32_bf16 v[76:79], a[236:239], v[136:139], v[76:79]
    s_add_u32 m0, s78, 8192
    s_add_u32 s72, s75, 2
    s_cmp_ge_u32 s72, 14
    s_cselect_b32 s71, 14, 0
    s_sub_u32 s72, s72, s71
    s_mul_i32 s72, s72, 131072
    s_add_u32 s71, s72, s3
    v_mfma_f32_16x16x32_bf16 v[56:59], a[248:251], v[96:99], v[56:59]
    buffer_load_dwordx4 v220, s[28:31], s71 offen offset:0  lds
    v_mfma_f32_16x16x32_bf16 v[76:79], a[252:255], v[96:99], v[76:79]
    ds_write_b128 v201, v[16:19] offset:24576
    s_waitcnt vmcnt(12)
    v_mfma_f32_16x16x32_bf16 v[20:23], a[224:227], v[140:143], v[20:23]
    ds_write_b128 v201, v[36:39] offset:25600
    v_mfma_f32_16x16x32_bf16 v[40:43], a[228:231], v[140:143], v[40:43]
    buffer_load_dwordx4 v221, s[28:31], s71 offen offset:1024  lds
    v_mfma_f32_16x16x32_bf16 v[20:23], a[240:243], v[100:103], v[20:23]
    buffer_load_dwordx4 v222, s[28:31], s71 offen offset:2048  lds
    v_mfma_f32_16x16x32_bf16 v[40:43], a[244:247], v[100:103], v[40:43]
    ds_write_b128 v201, v[56:59] offset:30720
    v_mfma_f32_16x16x32_bf16 v[60:63], a[232:235], v[140:143], v[60:63]
    ds_write_b128 v201, v[76:79] offset:31744
    v_mfma_f32_16x16x32_bf16 v[80:83], a[236:239], v[140:143], v[80:83]
    buffer_load_dwordx4 v223, s[28:31], s71 offen offset:3072  lds
    v_mfma_f32_16x16x32_bf16 v[60:63], a[248:251], v[100:103], v[60:63]
    v_mfma_f32_16x16x32_bf16 v[80:83], a[252:255], v[100:103], v[80:83]
    ds_write_b128 v201, v[20:23] offset:26624
    s_waitcnt vmcnt(14)
    v_mfma_f32_16x16x32_bf16 v[24:27], a[224:227], v[144:147], v[24:27]
    ds_write_b128 v201, v[40:43] offset:27648
    v_mfma_f32_16x16x32_bf16 v[44:47], a[228:231], v[144:147], v[44:47]
    v_mfma_f32_16x16x32_bf16 v[24:27], a[240:243], v[104:107], v[24:27]
    v_mfma_f32_16x16x32_bf16 v[44:47], a[244:247], v[104:107], v[44:47]
    v_mfma_f32_16x16x32_bf16 v[64:67], a[232:235], v[144:147], v[64:67]
    v_mfma_f32_16x16x32_bf16 v[84:87], a[236:239], v[144:147], v[84:87]
    ds_write_b128 v202, v[60:63] offset:16384
    v_mfma_f32_16x16x32_bf16 v[64:67], a[248:251], v[104:107], v[64:67]
    ds_write_b128 v202, v[80:83] offset:17408
    v_mfma_f32_16x16x32_bf16 v[84:87], a[252:255], v[104:107], v[84:87]
    s_waitcnt vmcnt(13)
    v_mfma_f32_16x16x32_bf16 v[68:71], a[232:235], v[148:151], v[68:71]
    v_mfma_f32_16x16x32_bf16 v[88:91], a[236:239], v[148:151], v[88:91]
    ds_write_b128 v201, v[24:27] offset:28672
    v_mfma_f32_16x16x32_bf16 v[68:71], a[248:251], v[108:111], v[68:71]
    ds_write_b128 v201, v[44:47] offset:29696
    v_mfma_f32_16x16x32_bf16 v[88:91], a[252:255], v[108:111], v[88:91]
    s_waitcnt vmcnt(11)
    v_mfma_f32_16x16x32_bf16 v[72:75], a[232:235], v[152:155], v[72:75]
    ds_write_b128 v202, v[64:67] offset:18432
    v_mfma_f32_16x16x32_bf16 v[92:95], a[236:239], v[152:155], v[92:95]
    ds_write_b128 v202, v[84:87] offset:19456
    v_mfma_f32_16x16x32_bf16 v[72:75], a[248:251], v[112:115], v[72:75]
    v_mfma_f32_16x16x32_bf16 v[92:95], a[252:255], v[112:115], v[92:95]
    v_mfma_f32_16x16x32_bf16 v[28:31], a[224:227], v[148:151], v[28:31]
    ds_write_b128 v202, v[68:71] offset:20480
    v_mfma_f32_16x16x32_bf16 v[48:51], a[228:231], v[148:151], v[48:51]
    ds_write_b128 v202, v[88:91] offset:21504
    v_mfma_f32_16x16x32_bf16 v[28:31], a[240:243], v[108:111], v[28:31]
    v_mfma_f32_16x16x32_bf16 v[48:51], a[244:247], v[108:111], v[48:51]
    v_mfma_f32_16x16x32_bf16 v[32:35], a[224:227], v[152:155], v[32:35]
    v_mfma_f32_16x16x32_bf16 v[52:55], a[228:231], v[152:155], v[52:55]
    ds_write_b128 v202, v[72:75] offset:22528
    v_mfma_f32_16x16x32_bf16 v[32:35], a[240:243], v[112:115], v[32:35]
    ds_write_b128 v202, v[92:95] offset:23552
    v_mfma_f32_16x16x32_bf16 v[52:55], a[244:247], v[112:115], v[52:55]
    s_add_u32 m0, s78, 12288
    s_add_u32 s72, s75, 3
    s_cmp_ge_u32 s72, 14
    s_cselect_b32 s77, 14, 0
    s_sub_u32 s72, s72, s77
    s_mul_i32 s72, s72, 131072
    s_add_u32 s77, s72, s3
    buffer_load_dwordx4 v220, s[28:31], s77 offen offset:0  lds
    buffer_load_dwordx4 v221, s[28:31], s77 offen offset:1024  lds
    buffer_load_dwordx4 v222, s[28:31], s77 offen offset:2048  lds
    buffer_load_dwordx4 v223, s[28:31], s77 offen offset:3072  lds
    s_waitcnt lgkmcnt(0)
    s_barrier
    ds_read_b128 v[96:99], v200 offset:24576
    ds_read_b128 v[100:103], v200 offset:25600
    ds_read_b128 v[104:107], v200 offset:63488
    ds_read_b128 v[108:111], v200 offset:64512
    ds_read_b128 v[112:115], v201 offset:63488
    ds_read_b128 v[116:119], v201 offset:64512
    ds_read_b128 v[120:123], v200 offset:26624
    ds_read_b128 v[124:127], v200 offset:27648
    ds_read_b128 v[128:131], v202 offset:8192
    ds_read_b128 v[132:135], v202 offset:9216
    ds_read_b128 v[136:139], v202 offset:24576
    ds_read_b128 v[140:143], v202 offset:25600
    v_lshlrev_b32 v206, 16, v10
    v_and_b32 v207, 0xffff0000, v10
    v_lshlrev_b32 v208, 16, v11
    v_and_b32 v209, 0xffff0000, v11
    v_lshlrev_b32 v210, 16, v12
    v_and_b32 v211, 0xffff0000, v12
    v_lshlrev_b32 v212, 16, v13
    v_and_b32 v213, 0xffff0000, v13
    v_pk_add_f32 v[28:29], v[28:29], v[206:207]
    v_pk_add_f32 v[30:31], v[30:31], v[208:209]
    v_pk_add_f32 v[48:49], v[48:49], v[210:211]
    v_pk_add_f32 v[50:51], v[50:51], v[212:213]
    v_pk_add_f32 v[32:33], v[32:33], v[206:207]
    v_pk_add_f32 v[34:35], v[34:35], v[208:209]
    v_pk_add_f32 v[52:53], v[52:53], v[210:211]
    v_pk_add_f32 v[54:55], v[54:55], v[212:213]
    s_waitcnt lgkmcnt(11)
    v_pk_add_f32 v[28:29], v[28:29], v[96:97]
    v_pk_add_f32 v[30:31], v[30:31], v[98:99]
    s_waitcnt lgkmcnt(10)
    v_pk_add_f32 v[48:49], v[48:49], v[100:101]
    v_pk_add_f32 v[50:51], v[50:51], v[102:103]
    s_waitcnt lgkmcnt(9)
    v_pk_add_f32 v[28:29], v[28:29], v[104:105]
    v_pk_add_f32 v[30:31], v[30:31], v[106:107]
    s_waitcnt lgkmcnt(8)
    v_pk_add_f32 v[48:49], v[48:49], v[108:109]
    v_pk_add_f32 v[50:51], v[50:51], v[110:111]
    s_waitcnt lgkmcnt(7)
    v_pk_add_f32 v[28:29], v[28:29], v[112:113]
    v_pk_add_f32 v[30:31], v[30:31], v[114:115]
    s_waitcnt lgkmcnt(6)
    v_pk_add_f32 v[48:49], v[48:49], v[116:117]
    v_pk_add_f32 v[50:51], v[50:51], v[118:119]
    s_waitcnt lgkmcnt(5)
    v_pk_add_f32 v[32:33], v[32:33], v[120:121]
    v_pk_add_f32 v[34:35], v[34:35], v[122:123]
    s_waitcnt lgkmcnt(4)
    v_pk_add_f32 v[52:53], v[52:53], v[124:125]
    v_pk_add_f32 v[54:55], v[54:55], v[126:127]
    s_waitcnt lgkmcnt(3)
    v_pk_add_f32 v[32:33], v[32:33], v[128:129]
    v_pk_add_f32 v[34:35], v[34:35], v[130:131]
    s_waitcnt lgkmcnt(2)
    v_pk_add_f32 v[52:53], v[52:53], v[132:133]
    v_pk_add_f32 v[54:55], v[54:55], v[134:135]
    s_waitcnt lgkmcnt(1)
    v_pk_add_f32 v[32:33], v[32:33], v[136:137]
    v_pk_add_f32 v[34:35], v[34:35], v[138:139]
    s_waitcnt lgkmcnt(0)
    v_pk_add_f32 v[52:53], v[52:53], v[140:141]
    v_pk_add_f32 v[54:55], v[54:55], v[142:143]
    s_barrier
    v_pk_mul_f32 v[96:97], v[28:29], v[28:29]
    v_pk_mul_f32 v[98:99], v[30:31], v[30:31]
    v_pk_mul_f32 v[100:101], v[48:49], v[48:49]
    v_pk_mul_f32 v[102:103], v[50:51], v[50:51]
    v_pk_mul_f32 v[104:105], v[32:33], v[32:33]
    v_pk_mul_f32 v[106:107], v[34:35], v[34:35]
    v_pk_mul_f32 v[108:109], v[52:53], v[52:53]
    v_pk_mul_f32 v[110:111], v[54:55], v[54:55]
    v_pk_fma_f32 v[96:97], v[96:97], s[100:101], v[204:205]
    v_pk_fma_f32 v[98:99], v[98:99], s[100:101], v[204:205]
    v_pk_fma_f32 v[100:101], v[100:101], s[100:101], v[204:205]
    v_pk_fma_f32 v[102:103], v[102:103], s[100:101], v[204:205]
    v_pk_fma_f32 v[104:105], v[104:105], s[100:101], v[204:205]
    v_pk_fma_f32 v[106:107], v[106:107], s[100:101], v[204:205]
    v_pk_fma_f32 v[108:109], v[108:109], s[100:101], v[204:205]
    v_pk_fma_f32 v[110:111], v[110:111], s[100:101], v[204:205]
    v_pk_mul_f32 v[96:97], v[96:97], v[28:29]
    v_pk_mul_f32 v[98:99], v[98:99], v[30:31]
    v_pk_mul_f32 v[100:101], v[100:101], v[48:49]
    v_pk_mul_f32 v[102:103], v[102:103], v[50:51]
    v_pk_mul_f32 v[104:105], v[104:105], v[32:33]
    v_pk_mul_f32 v[106:107], v[106:107], v[34:35]
    v_pk_mul_f32 v[108:109], v[108:109], v[52:53]
    v_pk_mul_f32 v[110:111], v[110:111], v[54:55]
    v_exp_f32 v96, v96
    v_exp_f32 v97, v97
    v_exp_f32 v98, v98
    v_exp_f32 v99, v99
    v_exp_f32 v100, v100
    v_exp_f32 v101, v101
    v_exp_f32 v102, v102
    v_exp_f32 v103, v103
    v_exp_f32 v104, v104
    v_exp_f32 v105, v105
    v_exp_f32 v106, v106
    v_exp_f32 v107, v107
    v_exp_f32 v108, v108
    v_exp_f32 v109, v109
    v_exp_f32 v110, v110
    v_exp_f32 v111, v111
    v_pk_add_f32 v[96:97], v[96:97], 1.0 op_sel_hi:[1,0]
    v_pk_add_f32 v[98:99], v[98:99], 1.0 op_sel_hi:[1,0]
    v_pk_add_f32 v[100:101], v[100:101], 1.0 op_sel_hi:[1,0]
    v_pk_add_f32 v[102:103], v[102:103], 1.0 op_sel_hi:[1,0]
    v_pk_add_f32 v[104:105], v[104:105], 1.0 op_sel_hi:[1,0]
    v_pk_add_f32 v[106:107], v[106:107], 1.0 op_sel_hi:[1,0]
    v_pk_add_f32 v[108:109], v[108:109], 1.0 op_sel_hi:[1,0]
    v_pk_add_f32 v[110:111], v[110:111], 1.0 op_sel_hi:[1,0]
    v_rcp_f32 v96, v96
    v_rcp_f32 v97, v97
    v_rcp_f32 v98, v98
    v_rcp_f32 v99, v99
    v_rcp_f32 v100, v100
    v_rcp_f32 v101, v101
    v_rcp_f32 v102, v102
    v_rcp_f32 v103, v103
    v_rcp_f32 v104, v104
    v_rcp_f32 v105, v105
    v_rcp_f32 v106, v106
    v_rcp_f32 v107, v107
    v_rcp_f32 v108, v108
    v_rcp_f32 v109, v109
    v_rcp_f32 v110, v110
    v_rcp_f32 v111, v111
    s_nop 0
    v_pk_mul_f32 v[28:29], v[28:29], v[96:97]
    v_pk_mul_f32 v[30:31], v[30:31], v[98:99]
    v_pk_mul_f32 v[48:49], v[48:49], v[100:101]
    v_pk_mul_f32 v[50:51], v[50:51], v[102:103]
    v_pk_mul_f32 v[32:33], v[32:33], v[104:105]
    v_pk_mul_f32 v[34:35], v[34:35], v[106:107]
    v_pk_mul_f32 v[52:53], v[52:53], v[108:109]
    v_pk_mul_f32 v[54:55], v[54:55], v[110:111]
    s_lshl_b32 s68, s63, 1
    s_add_u32 s68, s68, 0
    s_mul_i32 s68, s68, 40960
    s_mul_i32 s69, s64, 5120
    s_add_u32 s68, s68, s69
    v_cvt_pk_bf16_f32 v160, v28, v29
    v_cvt_pk_bf16_f32 v161, v30, v31
    v_cvt_pk_bf16_f32 v162, v48, v49
    v_cvt_pk_bf16_f32 v163, v50, v51
    s_add_u32 s69, s68, 3072
    buffer_store_dwordx4 v[160:163], v200, s[36:39], s69 offen sc1
    v_cvt_pk_bf16_f32 v164, v32, v33
    v_cvt_pk_bf16_f32 v165, v34, v35
    v_cvt_pk_bf16_f32 v166, v52, v53
    v_cvt_pk_bf16_f32 v167, v54, v55
    s_add_u32 s69, s68, 4096
    buffer_store_dwordx4 v[164:167], v200, s[36:39], s69 offen sc1
    s_add_u32 m0, s78, 16384
    s_add_u32 s72, s75, 4
    s_cmp_ge_u32 s72, 14
    s_cselect_b32 s77, 14, 0
    s_sub_u32 s72, s72, s77
    s_mul_i32 s72, s72, 131072
    s_add_u32 s77, s72, s3
    buffer_load_dwordx4 v220, s[28:31], s77 offen offset:0  lds
    buffer_load_dwordx4 v221, s[28:31], s77 offen offset:1024  lds
    buffer_load_dwordx4 v222, s[28:31], s77 offen offset:2048  lds
    buffer_load_dwordx4 v223, s[28:31], s77 offen offset:3072  lds
    s_add_u32 m0, s78, 20480
    s_add_u32 s72, s75, 5
    s_cmp_ge_u32 s72, 14
    s_cselect_b32 s77, 14, 0
    s_sub_u32 s72, s72, s77
    s_mul_i32 s72, s72, 131072
    s_add_u32 s77, s72, s3
    buffer_load_dwordx4 v220, s[28:31], s77 offen offset:0  lds
    buffer_load_dwordx4 v221, s[28:31], s77 offen offset:1024  lds
    buffer_load_dwordx4 v222, s[28:31], s77 offen offset:2048  lds
    buffer_load_dwordx4 v223, s[28:31], s77 offen offset:3072  lds
    s_waitcnt vmcnt(10)
    ds_read_b64_tr_b16 a[0:1], v2 offset:0
    ds_read_b64_tr_b16 a[2:3], v2 offset:2048
    ds_read_b64_tr_b16 a[4:5], v3 offset:0
    ds_read_b64_tr_b16 a[6:7], v3 offset:2048
    ds_read_b64_tr_b16 a[8:9], v4 offset:0
    ds_read_b64_tr_b16 a[10:11], v4 offset:2048
    ds_read_b64_tr_b16 a[12:13], v5 offset:0
    ds_read_b64_tr_b16 a[14:15], v5 offset:2048
    ds_read_b64_tr_b16 a[16:17], v2 offset:4096
    ds_read_b64_tr_b16 a[18:19], v2 offset:6144
    ds_read_b64_tr_b16 a[20:21], v3 offset:4096
    ds_read_b64_tr_b16 a[22:23], v3 offset:6144
    ds_read_b64_tr_b16 a[24:25], v4 offset:4096
    ds_read_b64_tr_b16 a[26:27], v4 offset:6144
    ds_read_b64_tr_b16 a[28:29], v5 offset:4096
    ds_read_b64_tr_b16 a[30:31], v5 offset:6144
    s_waitcnt lgkmcnt(0)
    ds_read_b64_tr_b16 a[32:33], v2 offset:8192
    ds_read_b64_tr_b16 a[34:35], v2 offset:10240
    ds_read_b64_tr_b16 a[36:37], v3 offset:8192
    ds_read_b64_tr_b16 a[38:39], v3 offset:10240
    ds_read_b64_tr_b16 a[40:41], v4 offset:8192
    ds_read_b64_tr_b16 a[42:43], v4 offset:10240
    ds_read_b64_tr_b16 a[44:45], v5 offset:8192
    ds_read_b64_tr_b16 a[46:47], v5 offset:10240
    ds_read_b64_tr_b16 a[48:49], v2 offset:12288
    ds_read_b64_tr_b16 a[50:51], v2 offset:14336
    ds_read_b64_tr_b16 a[52:53], v3 offset:12288
    ds_read_b64_tr_b16 a[54:55], v3 offset:14336
    ds_read_b64_tr_b16 a[56:57], v4 offset:12288
    ds_read_b64_tr_b16 a[58:59], v4 offset:14336
    ds_read_b64_tr_b16 a[60:61], v5 offset:12288
    ds_read_b64_tr_b16 a[62:63], v5 offset:14336
    s_waitcnt lgkmcnt(0)
    s_waitcnt vmcnt(8)
    s_barrier
    s_add_u32 m0, s78, 24576
    s_add_u32 s72, s75, 6
    s_cmp_ge_u32 s72, 14
    s_cselect_b32 s77, 14, 0
    s_sub_u32 s72, s72, s77
    s_mul_i32 s72, s72, 131072
    s_add_u32 s77, s72, s3
    buffer_load_dwordx4 v220, s[28:31], s77 offen offset:0  lds
    buffer_load_dwordx4 v221, s[28:31], s77 offen offset:1024  lds
    buffer_load_dwordx4 v222, s[28:31], s77 offen offset:2048  lds
    buffer_load_dwordx4 v223, s[28:31], s77 offen offset:3072  lds
    s_add_u32 m0, s78, 28672
    s_add_u32 s72, s75, 7
    s_cmp_ge_u32 s72, 14
    s_cselect_b32 s77, 14, 0
    s_sub_u32 s72, s72, s77
    s_mul_i32 s72, s72, 131072
    s_add_u32 s77, s72, s3
    buffer_load_dwordx4 v220, s[28:31], s77 offen offset:0  lds
    buffer_load_dwordx4 v221, s[28:31], s77 offen offset:1024  lds
    buffer_load_dwordx4 v222, s[28:31], s77 offen offset:2048  lds
    buffer_load_dwordx4 v223, s[28:31], s77 offen offset:3072  lds
    s_add_u32 m0, s99, 0
    s_add_u32 s72, s75, 8
    s_cmp_ge_u32 s72, 14
    s_cselect_b32 s77, 14, 0
    s_sub_u32 s72, s72, s77
    s_mul_i32 s72, s72, 131072
    s_add_u32 s77, s72, s3
    buffer_load_dwordx4 v220, s[28:31], s77 offen offset:0  lds
    buffer_load_dwordx4 v221, s[28:31], s77 offen offset:1024  lds
    buffer_load_dwordx4 v222, s[28:31], s77 offen offset:2048  lds
    buffer_load_dwordx4 v223, s[28:31], s77 offen offset:3072  lds
    s_add_u32 m0, s99, 4096
    s_add_u32 s72, s75, 9
    s_cmp_ge_u32 s72, 14
    s_cselect_b32 s77, 14, 0
    s_sub_u32 s72, s72, s77
    s_mul_i32 s72, s72, 131072
    s_add_u32 s77, s72, s3
    buffer_load_dwordx4 v220, s[28:31], s77 offen offset:0  lds
    buffer_load_dwordx4 v221, s[28:31], s77 offen offset:1024  lds
    buffer_load_dwordx4 v222, s[28:31], s77 offen offset:2048  lds
    buffer_load_dwordx4 v223, s[28:31], s77 offen offset:3072  lds
    s_add_u32 m0, s78, 0
    s_add_u32 s72, s75, 10
    s_cmp_ge_u32 s72, 14
    s_cselect_b32 s77, 14, 0
    s_sub_u32 s72, s72, s77
    s_mul_i32 s72, s72, 131072
    s_add_u32 s77, s72, s3
    buffer_load_dwordx4 v220, s[28:31], s77 offen offset:0  lds
    buffer_load_dwordx4 v221, s[28:31], s77 offen offset:1024  lds
    buffer_load_dwordx4 v222, s[28:31], s77 offen offset:2048  lds
    buffer_load_dwordx4 v223, s[28:31], s77 offen offset:3072  lds
    s_add_u32 m0, s78, 4096
    s_add_u32 s72, s75, 11
    s_cmp_ge_u32 s72, 14
    s_cselect_b32 s77, 14, 0
    s_sub_u32 s72, s72, s77
    s_mul_i32 s72, s72, 131072
    s_add_u32 s77, s72, s3
    buffer_load_dwordx4 v220, s[28:31], s77 offen offset:0  lds
    buffer_load_dwordx4 v221, s[28:31], s77 offen offset:1024  lds
    buffer_load_dwordx4 v222, s[28:31], s77 offen offset:2048  lds
    buffer_load_dwordx4 v223, s[28:31], s77 offen offset:3072  lds
    s_add_u32 m0, s78, 8192
    s_add_u32 s72, s75, 12
    s_cmp_ge_u32 s72, 14
    s_cselect_b32 s77, 14, 0
    s_sub_u32 s72, s72, s77
    s_mul_i32 s72, s72, 131072
    s_add_u32 s77, s72, s3
    buffer_load_dwordx4 v220, s[28:31], s77 offen offset:0  lds
    buffer_load_dwordx4 v221, s[28:31], s77 offen offset:1024  lds
    buffer_load_dwordx4 v222, s[28:31], s77 offen offset:2048  lds
    buffer_load_dwordx4 v223, s[28:31], s77 offen offset:3072  lds
    s_add_u32 m0, s78, 12288
    s_add_u32 s72, s75, 13
    s_cmp_ge_u32 s72, 14
    s_cselect_b32 s77, 14, 0
    s_sub_u32 s72, s72, s77
    s_mul_i32 s72, s72, 131072
    s_add_u32 s77, s72, s3
    buffer_load_dwordx4 v220, s[28:31], s77 offen offset:0  lds
    buffer_load_dwordx4 v221, s[28:31], s77 offen offset:1024  lds
    buffer_load_dwordx4 v222, s[28:31], s77 offen offset:2048  lds
    buffer_load_dwordx4 v223, s[28:31], s77 offen offset:3072  lds
    s_waitcnt vmcnt(36)
    ds_read_b64_tr_b16 a[64:65], v2 offset:16384
    ds_read_b64_tr_b16 a[66:67], v2 offset:18432
    ds_read_b64_tr_b16 a[68:69], v3 offset:16384
    ds_read_b64_tr_b16 a[70:71], v3 offset:18432
    ds_read_b64_tr_b16 a[72:73], v4 offset:16384
    ds_read_b64_tr_b16 a[74:75], v4 offset:18432
    ds_read_b64_tr_b16 a[76:77], v5 offset:16384
    ds_read_b64_tr_b16 a[78:79], v5 offset:18432
    s_waitcnt vmcnt(32)
    ds_read_b64_tr_b16 a[80:81], v2 offset:20480
    ds_read_b64_tr_b16 a[82:83], v2 offset:22528
    ds_read_b64_tr_b16 a[84:85], v3 offset:20480
    ds_read_b64_tr_b16 a[86:87], v3 offset:22528
    ds_read_b64_tr_b16 a[88:89], v4 offset:20480
    ds_read_b64_tr_b16 a[90:91], v4 offset:22528
    ds_read_b64_tr_b16 a[92:93], v5 offset:20480
    ds_read_b64_tr_b16 a[94:95], v5 offset:22528
    s_waitcnt lgkmcnt(0)
    s_waitcnt vmcnt(28)
    ds_read_b64_tr_b16 a[96:97], v2 offset:24576
    ds_read_b64_tr_b16 a[98:99], v2 offset:26624
    ds_read_b64_tr_b16 a[100:101], v3 offset:24576
    ds_read_b64_tr_b16 a[102:103], v3 offset:26624
    ds_read_b64_tr_b16 a[104:105], v4 offset:24576
    ds_read_b64_tr_b16 a[106:107], v4 offset:26624
    ds_read_b64_tr_b16 a[108:109], v5 offset:24576
    ds_read_b64_tr_b16 a[110:111], v5 offset:26624
    s_waitcnt vmcnt(24)
    ds_read_b64_tr_b16 a[112:113], v2 offset:28672
    ds_read_b64_tr_b16 a[114:115], v2 offset:30720
    ds_read_b64_tr_b16 a[116:117], v3 offset:28672
    ds_read_b64_tr_b16 a[118:119], v3 offset:30720
    ds_read_b64_tr_b16 a[120:121], v4 offset:28672
    ds_read_b64_tr_b16 a[122:123], v4 offset:30720
    ds_read_b64_tr_b16 a[124:125], v5 offset:28672
    ds_read_b64_tr_b16 a[126:127], v5 offset:30720
    s_waitcnt lgkmcnt(0)
    s_waitcnt vmcnt(20)
    ds_read_b64_tr_b16 a[128:129], v196 offset:0
    ds_read_b64_tr_b16 a[130:131], v196 offset:2048
    ds_read_b64_tr_b16 a[132:133], v197 offset:0
    ds_read_b64_tr_b16 a[134:135], v197 offset:2048
    ds_read_b64_tr_b16 a[136:137], v198 offset:0
    ds_read_b64_tr_b16 a[138:139], v198 offset:2048
    ds_read_b64_tr_b16 a[140:141], v199 offset:0
    ds_read_b64_tr_b16 a[142:143], v199 offset:2048
    s_waitcnt vmcnt(16)
    ds_read_b64_tr_b16 a[144:145], v196 offset:4096
    ds_read_b64_tr_b16 a[146:147], v196 offset:6144
    ds_read_b64_tr_b16 a[148:149], v197 offset:4096
    ds_read_b64_tr_b16 a[150:151], v197 offset:6144
    ds_read_b64_tr_b16 a[152:153], v198 offset:4096
    ds_read_b64_tr_b16 a[154:155], v198 offset:6144
    ds_read_b64_tr_b16 a[156:157], v199 offset:4096
    ds_read_b64_tr_b16 a[158:159], v199 offset:6144
    s_waitcnt lgkmcnt(0)
    s_branch L_pre2
L_ep1_3:
    s_waitcnt vmcnt(13)
    s_waitcnt vmcnt(8)
    v_mfma_f32_16x16x32_bf16 v[16:19], a[224:227], v[136:139], v[16:19]
    s_add_u32 m0, s78, 4096
    s_add_u32 s72, s75, 1
    s_cmp_ge_u32 s72, 14
    s_cselect_b32 s71, 14, 0
    s_sub_u32 s72, s72, s71
    s_mul_i32 s72, s72, 131072
    s_add_u32 s71, s72, s3
    v_mfma_f32_16x16x32_bf16 v[36:39], a[228:231], v[136:139], v[36:39]
    buffer_load_dwordx4 v220, s[28:31], s71 offen offset:0  lds
    v_mfma_f32_16x16x32_bf16 v[16:19], a[240:243], v[96:99], v[16:19]
    buffer_load_dwordx4 v221, s[28:31], s71 offen offset:1024  lds
    v_mfma_f32_16x16x32_bf16 v[36:39], a[244:247], v[96:99], v[36:39]
    buffer_load_dwordx4 v222, s[28:31], s71 offen offset:2048  lds
    v_mfma_f32_16x16x32_bf16 v[56:59], a[232:235], v[136:139], v[56:59]
    buffer_load_dwordx4 v223, s[28:31], s71 offen offset:3072  lds
    v_mfma_f32_16x16x32_bf16 v[76:79], a[236:239], v[136:139], v[76:79]
    s_add_u32 m0, s78, 8192
    s_add_u32 s72, s75, 2
    s_cmp_ge_u32 s72, 14
    s_cselect_b32 s71, 14, 0
    s_sub_u32 s72, s72, s71
    s_mul_i32 s72, s72, 131072
    s_add_u32 s71, s72, s3
    v_mfma_f32_16x16x32_bf16 v[56:59], a[248:251], v[96:99], v[56:59]
    buffer_load_dwordx4 v220, s[28:31], s71 offen offset:0  lds
    v_mfma_f32_16x16x32_bf16 v[76:79], a[252:255], v[96:99], v[76:79]
    ds_write_b128 v201, v[16:19] offset:57344
    s_waitcnt vmcnt(12)
    v_mfma_f32_16x16x32_bf16 v[20:23], a[224:227], v[140:143], v[20:23]
    ds_write_b128 v201, v[36:39] offset:58368
    v_mfma_f32_16x16x32_bf16 v[40:43], a[228:231], v[140:143], v[40:43]
    buffer_load_dwordx4 v221, s[28:31], s71 offen offset:1024  lds
    v_mfma_f32_16x16x32_bf16 v[20:23], a[240:243], v[100:103], v[20:23]
    buffer_load_dwordx4 v222, s[28:31], s71 offen offset:2048  lds
    v_mfma_f32_16x16x32_bf16 v[40:43], a[244:247], v[100:103], v[40:43]
    ds_write_b128 v202, v[56:59] offset:26624
    v_mfma_f32_16x16x32_bf16 v[60:63], a[232:235], v[140:143], v[60:63]
    ds_write_b128 v202, v[76:79] offset:27648
    v_mfma_f32_16x16x32_bf16 v[80:83], a[236:239], v[140:143], v[80:83]
    buffer_load_dwordx4 v223, s[28:31], s71 offen offset:3072  lds
    v_mfma_f32_16x16x32_bf16 v[60:63], a[248:251], v[100:103], v[60:63]
    v_mfma_f32_16x16x32_bf16 v[80:83], a[252:255], v[100:103], v[80:83]
    ds_write_b128 v201, v[20:23] offset:59392
    s_waitcnt vmcnt(14)
    v_mfma_f32_16x16x32_bf16 v[24:27], a[224:227], v[144:147], v[24:27]
    ds_write_b128 v201, v[40:43] offset:60416
    v_mfma_f32_16x16x32_bf16 v[44:47], a[228:231], v[144:147], v[44:47]
    v_mfma_f32_16x16x32_bf16 v[24:27], a[240:243], v[104:107], v[24:27]
    v_mfma_f32_16x16x32_bf16 v[44:47], a[244:247], v[104:107], v[44:47]
    v_mfma_f32_16x16x32_bf16 v[64:67], a[232:235], v[144:147], v[64:67]
    v_mfma_f32_16x16x32_bf16 v[84:87], a[236:239], v[144:147], v[84:87]
    ds_write_b128 v202, v[60:63] offset:28672
    v_mfma_f32_16x16x32_bf16 v[64:67], a[248:251], v[104:107], v[64:67]
    ds_write_b128 v202, v[80:83] offset:29696
    v_mfma_f32_16x16x32_bf16 v[84:87], a[252:255], v[104:107], v[84:87]
    s_waitcnt vmcnt(13)
    v_mfma_f32_16x16x32_bf16 v[28:31], a[224:227], v[148:151], v[28:31]
    v_mfma_f32_16x16x32_bf16 v[48:51], a[228:231], v[148:151], v[48:51]
    ds_write_b128 v201, v[24:27] offset:61440
    v_mfma_f32_16x16x32_bf16 v[28:31], a[240:243], v[108:111], v[28:31]
    ds_write_b128 v201, v[44:47] offset:62464
    v_mfma_f32_16x16x32_bf16 v[48:51], a[244:247], v[108:111], v[48:51]
    s_waitcnt vmcnt(11)
    v_mfma_f32_16x16x32_bf16 v[32:35], a[224:227], v[152:155], v[32:35]
    ds_write_b128 v202, v[64:67] offset:30720
    v_mfma_f32_16x16x32_bf16 v[52:55], a[228:231], v[152:155], v[52:55]
    ds_write_b128 v202, v[84:87] offset:31744
    v_mfma_f32_16x16x32_bf16 v[32:35], a[240:243], v[112:115], v[32:35]
    v_mfma_f32_16x16x32_bf16 v[52:55], a[244:247], v[112:115], v[52:55]
    v_mfma_f32_16x16x32_bf16 v[68:71], a[232:235], v[148:151], v[68:71]
    ds_write_b128 v201, v[28:31] offset:63488
    v_mfma_f32_16x16x32_bf16 v[88:91], a[236:239], v[148:151], v[88:91]
    ds_write_b128 v201, v[48:51] offset:64512
    v_mfma_f32_16x16x32_bf16 v[68:71], a[248:251], v[108:111], v[68:71]
    v_mfma_f32_16x16x32_bf16 v[88:91], a[252:255], v[108:111], v[88:91]
    v_mfma_f32_16x16x32_bf16 v[72:75], a[232:235], v[152:155], v[72:75]
    v_mfma_f32_16x16x32_bf16 v[92:95], a[236:239], v[152:155], v[92:95]
    ds_write_b128 v202, v[32:35] offset:24576
    v_mfma_f32_16x16x32_bf16 v[72:75], a[248:251], v[112:115], v[72:75]
    ds_write_b128 v202, v[52:55] offset:25600
    v_mfma_f32_16x16x32_bf16 v[92:95], a[252:255], v[112:115], v[92:95]
    s_add_u32 m0, s78, 12288
    s_add_u32 s72, s75, 3
    s_cmp_ge_u32 s72, 14
    s_cselect_b32 s77, 14, 0
    s_sub_u32 s72, s72, s77
    s_mul_i32 s72, s72, 131072
    s_add_u32 s77, s72, s3
    buffer_load_dwordx4 v220, s[28:31], s77 offen offset:0  lds
    buffer_load_dwordx4 v221, s[28:31], s77 offen offset:1024  lds
    buffer_load_dwordx4 v222, s[28:31], s77 offen offset:2048  lds
    buffer_load_dwordx4 v223, s[28:31], s77 offen offset:3072  lds
    s_waitcnt lgkmcnt(0)
    s_barrier
    ds_read_b128 v[96:99], v202 offset:2048
    ds_read_b128 v[100:103], v202 offset:3072
    ds_read_b128 v[104:107], v202 offset:10240
    ds_read_b128 v[108:111], v202 offset:11264
    ds_read_b128 v[112:115], v202 offset:20480
    ds_read_b128 v[116:119], v202 offset:21504
    ds_read_b128 v[120:123], v202 offset:4096
    ds_read_b128 v[124:127], v202 offset:5120
    ds_read_b128 v[128:131], v202 offset:12288
    ds_read_b128 v[132:135], v202 offset:13312
    ds_read_b128 v[136:139], v202 offset:22528
    ds_read_b128 v[140:143], v202 offset:23552
    v_lshlrev_b32 v206, 16, v10
    v_and_b32 v207, 0xffff0000, v10
    v_lshlrev_b32 v208, 16, v11
    v_and_b32 v209, 0xffff0000, v11
    v_lshlrev_b32 v210, 16, v12
    v_and_b32 v211, 0xffff0000, v12
    v_lshlrev_b32 v212, 16, v13
    v_and_b32 v213, 0xffff0000, v13
    v_pk_add_f32 v[68:69], v[68:69], v[206:207]
    v_pk_add_f32 v[70:71], v[70:71], v[208:209]
    v_pk_add_f32 v[88:89], v[88:89], v[210:211]
    v_pk_add_f32 v[90:91], v[90:91], v[212:213]
    v_pk_add_f32 v[72:73], v[72:73], v[206:207]
    v_pk_add_f32 v[74:75], v[74:75], v[208:209]
    v_pk_add_f32 v[92:93], v[92:93], v[210:211]
    v_pk_add_f32 v[94:95], v[94:95], v[212:213]
    s_waitcnt lgkmcnt(11)
    v_pk_add_f32 v[68:69], v[68:69], v[96:97]
    v_pk_add_f32 v[70:71], v[70:71], v[98:99]
    s_waitcnt lgkmcnt(10)
    v_pk_add_f32 v[88:89], v[88:89], v[100:101]
    v_pk_add_f32 v[90:91], v[90:91], v[102:103]
    s_waitcnt lgkmcnt(9)
    v_pk_add_f32 v[68:69], v[68:69], v[104:105]
    v_pk_add_f32 v[70:71], v[70:71], v[106:107]
    s_waitcnt lgkmcnt(8)
    v_pk_add_f32 v[88:89], v[88:89], v[108:109]
    v_pk_add_f32 v[90:91], v[90:91], v[110:111]
    s_waitcnt lgkmcnt(7)
    v_pk_add_f32 v[68:69], v[68:69], v[112:113]
    v_pk_add_f32 v[70:71], v[70:71], v[114:115]
    s_waitcnt lgkmcnt(6)
    v_pk_add_f32 v[88:89], v[88:89], v[116:117]
    v_pk_add_f32 v[90:91], v[90:91], v[118:119]
    s_waitcnt lgkmcnt(5)
    v_pk_add_f32 v[72:73], v[72:73], v[120:121]
    v_pk_add_f32 v[74:75], v[74:75], v[122:123]
    s_waitcnt lgkmcnt(4)
    v_pk_add_f32 v[92:93], v[92:93], v[124:125]
    v_pk_add_f32 v[94:95], v[94:95], v[126:127]
    s_waitcnt lgkmcnt(3)
    v_pk_add_f32 v[72:73], v[72:73], v[128:129]
    v_pk_add_f32 v[74:75], v[74:75], v[130:131]
    s_waitcnt lgkmcnt(2)
    v_pk_add_f32 v[92:93], v[92:93], v[132:133]
    v_pk_add_f32 v[94:95], v[94:95], v[134:135]
    s_waitcnt lgkmcnt(1)
    v_pk_add_f32 v[72:73], v[72:73], v[136:137]
    v_pk_add_f32 v[74:75], v[74:75], v[138:139]
    s_waitcnt lgkmcnt(0)
    v_pk_add_f32 v[92:93], v[92:93], v[140:141]
    v_pk_add_f32 v[94:95], v[94:95], v[142:143]
    s_barrier
    v_pk_mul_f32 v[96:97], v[68:69], v[68:69]
    v_pk_mul_f32 v[98:99], v[70:71], v[70:71]
    v_pk_mul_f32 v[100:101], v[88:89], v[88:89]
    v_pk_mul_f32 v[102:103], v[90:91], v[90:91]
    v_pk_mul_f32 v[104:105], v[72:73], v[72:73]
    v_pk_mul_f32 v[106:107], v[74:75], v[74:75]
    v_pk_mul_f32 v[108:109], v[92:93], v[92:93]
    v_pk_mul_f32 v[110:111], v[94:95], v[94:95]
    v_pk_fma_f32 v[96:97], v[96:97], s[100:101], v[204:205]
    v_pk_fma_f32 v[98:99], v[98:99], s[100:101], v[204:205]
    v_pk_fma_f32 v[100:101], v[100:101], s[100:101], v[204:205]
    v_pk_fma_f32 v[102:103], v[102:103], s[100:101], v[204:205]
    v_pk_fma_f32 v[104:105], v[104:105], s[100:101], v[204:205]
    v_pk_fma_f32 v[106:107], v[106:107], s[100:101], v[204:205]
    v_pk_fma_f32 v[108:109], v[108:109], s[100:101], v[204:205]
    v_pk_fma_f32 v[110:111], v[110:111], s[100:101], v[204:205]
    v_pk_mul_f32 v[96:97], v[96:97], v[68:69]
    v_pk_mul_f32 v[98:99], v[98:99], v[70:71]
    v_pk_mul_f32 v[100:101], v[100:101], v[88:89]
    v_pk_mul_f32 v[102:103], v[102:103], v[90:91]
    v_pk_mul_f32 v[104:105], v[104:105], v[72:73]
    v_pk_mul_f32 v[106:107], v[106:107], v[74:75]
    v_pk_mul_f32 v[108:109], v[108:109], v[92:93]
    v_pk_mul_f32 v[110:111], v[110:111], v[94:95]
    v_exp_f32 v96, v96
    v_exp_f32 v97, v97
    v_exp_f32 v98, v98
    v_exp_f32 v99, v99
    v_exp_f32 v100, v100
    v_exp_f32 v101, v101
    v_exp_f32 v102, v102
    v_exp_f32 v103, v103
    v_exp_f32 v104, v104
    v_exp_f32 v105, v105
    v_exp_f32 v106, v106
    v_exp_f32 v107, v107
    v_exp_f32 v108, v108
    v_exp_f32 v109, v109
    v_exp_f32 v110, v110
    v_exp_f32 v111, v111
    v_pk_add_f32 v[96:97], v[96:97], 1.0 op_sel_hi:[1,0]
    v_pk_add_f32 v[98:99], v[98:99], 1.0 op_sel_hi:[1,0]
    v_pk_add_f32 v[100:101], v[100:101], 1.0 op_sel_hi:[1,0]
    v_pk_add_f32 v[102:103], v[102:103], 1.0 op_sel_hi:[1,0]
    v_pk_add_f32 v[104:105], v[104:105], 1.0 op_sel_hi:[1,0]
    v_pk_add_f32 v[106:107], v[106:107], 1.0 op_sel_hi:[1,0]
    v_pk_add_f32 v[108:109], v[108:109], 1.0 op_sel_hi:[1,0]
    v_pk_add_f32 v[110:111], v[110:111], 1.0 op_sel_hi:[1,0]
    v_rcp_f32 v96, v96
    v_rcp_f32 v97, v97
    v_rcp_f32 v98, v98
    v_rcp_f32 v99, v99
    v_rcp_f32 v100, v100
    v_rcp_f32 v101, v101
    v_rcp_f32 v102, v102
    v_rcp_f32 v103, v103
    v_rcp_f32 v104, v104
    v_rcp_f32 v105, v105
    v_rcp_f32 v106, v106
    v_rcp_f32 v107, v107
    v_rcp_f32 v108, v108
    v_rcp_f32 v109, v109
    v_rcp_f32 v110, v110
    v_rcp_f32 v111, v111
    s_nop 0
    v_pk_mul_f32 v[68:69], v[68:69], v[96:97]
    v_pk_mul_f32 v[70:71], v[70:71], v[98:99]
    v_pk_mul_f32 v[88:89], v[88:89], v[100:101]
    v_pk_mul_f32 v[90:91], v[90:91], v[102:103]
    v_pk_mul_f32 v[72:73], v[72:73], v[104:105]
    v_pk_mul_f32 v[74:75], v[74:75], v[106:107]
    v_pk_mul_f32 v[92:93], v[92:93], v[108:109]
    v_pk_mul_f32 v[94:95], v[94:95], v[110:111]
    s_lshl_b32 s68, s63, 1
    s_add_u32 s68, s68, 1
    s_mul_i32 s68, s68, 40960
    s_mul_i32 s69, s64, 5120
    s_add_u32 s68, s68, s69
    v_cvt_pk_bf16_f32 v160, v68, v69
    v_cvt_pk_bf16_f32 v161, v70, v71
    v_cvt_pk_bf16_f32 v162, v88, v89
    v_cvt_pk_bf16_f32 v163, v90, v91
    s_add_u32 s69, s68, 3072
    buffer_store_dwordx4 v[160:163], v200, s[36:39], s69 offen sc1
    v_cvt_pk_bf16_f32 v164, v72, v73
    v_cvt_pk_bf16_f32 v165, v74, v75
    v_cvt_pk_bf16_f32 v166, v92, v93
    v_cvt_pk_bf16_f32 v167, v94, v95
    s_add_u32 s69, s68, 4096
    buffer_store_dwordx4 v[164:167], v200, s[36:39], s69 offen sc1
    s_add_u32 m0, s78, 16384
    s_add_u32 s72, s75, 4
    s_cmp_ge_u32 s72, 14
    s_cselect_b32 s77, 14, 0
    s_sub_u32 s72, s72, s77
    s_mul_i32 s72, s72, 131072
    s_add_u32 s77, s72, s3
    buffer_load_dwordx4 v220, s[28:31], s77 offen offset:0  lds
    buffer_load_dwordx4 v221, s[28:31], s77 offen offset:1024  lds
    buffer_load_dwordx4 v222, s[28:31], s77 offen offset:2048  lds
    buffer_load_dwordx4 v223, s[28:31], s77 offen offset:3072  lds
    s_add_u32 m0, s78, 20480
    s_add_u32 s72, s75, 5
    s_cmp_ge_u32 s72, 14
    s_cselect_b32 s77, 14, 0
    s_sub_u32 s72, s72, s77
    s_mul_i32 s72, s72, 131072
    s_add_u32 s77, s72, s3
    buffer_load_dwordx4 v220, s[28:31], s77 offen offset:0  lds
    buffer_load_dwordx4 v221, s[28:31], s77 offen offset:1024  lds
    buffer_load_dwordx4 v222, s[28:31], s77 offen offset:2048  lds
    buffer_load_dwordx4 v223, s[28:31], s77 offen offset:3072  lds
    s_waitcnt vmcnt(10)
    ds_read_b64_tr_b16 a[0:1], v2 offset:0
    ds_read_b64_tr_b16 a[2:3], v2 offset:2048
    ds_read_b64_tr_b16 a[4:5], v3 offset:0
    ds_read_b64_tr_b16 a[6:7], v3 offset:2048
    ds_read_b64_tr_b16 a[8:9], v4 offset:0
    ds_read_b64_tr_b16 a[10:11], v4 offset:2048
    ds_read_b64_tr_b16 a[12:13], v5 offset:0
    ds_read_b64_tr_b16 a[14:15], v5 offset:2048
    ds_read_b64_tr_b16 a[16:17], v2 offset:4096
    ds_read_b64_tr_b16 a[18:19], v2 offset:6144
    ds_read_b64_tr_b16 a[20:21], v3 offset:4096
    ds_read_b64_tr_b16 a[22:23], v3 offset:6144
    ds_read_b64_tr_b16 a[24:25], v4 offset:4096
    ds_read_b64_tr_b16 a[26:27], v4 offset:6144
    ds_read_b64_tr_b16 a[28:29], v5 offset:4096
    ds_read_b64_tr_b16 a[30:31], v5 offset:6144
    s_waitcnt lgkmcnt(0)
    ds_read_b64_tr_b16 a[32:33], v2 offset:8192
    ds_read_b64_tr_b16 a[34:35], v2 offset:10240
    ds_read_b64_tr_b16 a[36:37], v3 offset:8192
    ds_read_b64_tr_b16 a[38:39], v3 offset:10240
    ds_read_b64_tr_b16 a[40:41], v4 offset:8192
    ds_read_b64_tr_b16 a[42:43], v4 offset:10240
    ds_read_b64_tr_b16 a[44:45], v5 offset:8192
    ds_read_b64_tr_b16 a[46:47], v5 offset:10240
    ds_read_b64_tr_b16 a[48:49], v2 offset:12288
    ds_read_b64_tr_b16 a[50:51], v2 offset:14336
    ds_read_b64_tr_b16 a[52:53], v3 offset:12288
    ds_read_b64_tr_b16 a[54:55], v3 offset:14336
    ds_read_b64_tr_b16 a[56:57], v4 offset:12288
    ds_read_b64_tr_b16 a[58:59], v4 offset:14336
    ds_read_b64_tr_b16 a[60:61], v5 offset:12288
    ds_read_b64_tr_b16 a[62:63], v5 offset:14336
    s_waitcnt lgkmcnt(0)
    s_waitcnt vmcnt(8)
    s_barrier
    s_add_u32 m0, s78, 24576
    s_add_u32 s72, s75, 6
    s_cmp_ge_u32 s72, 14
    s_cselect_b32 s77, 14, 0
    s_sub_u32 s72, s72, s77
    s_mul_i32 s72, s72, 131072
    s_add_u32 s77, s72, s3
    buffer_load_dwordx4 v220, s[28:31], s77 offen offset:0  lds
    buffer_load_dwordx4 v221, s[28:31], s77 offen offset:1024  lds
    buffer_load_dwordx4 v222, s[28:31], s77 offen offset:2048  lds
    buffer_load_dwordx4 v223, s[28:31], s77 offen offset:3072  lds
    s_add_u32 m0, s78, 28672
    s_add_u32 s72, s75, 7
    s_cmp_ge_u32 s72, 14
    s_cselect_b32 s77, 14, 0
    s_sub_u32 s72, s72, s77
    s_mul_i32 s72, s72, 131072
    s_add_u32 s77, s72, s3
    buffer_load_dwordx4 v220, s[28:31], s77 offen offset:0  lds
    buffer_load_dwordx4 v221, s[28:31], s77 offen offset:1024  lds
    buffer_load_dwordx4 v222, s[28:31], s77 offen offset:2048  lds
    buffer_load_dwordx4 v223, s[28:31], s77 offen offset:3072  lds
    s_add_u32 m0, s99, 0
    s_add_u32 s72, s75, 8
    s_cmp_ge_u32 s72, 14
    s_cselect_b32 s77, 14, 0
    s_sub_u32 s72, s72, s77
    s_mul_i32 s72, s72, 131072
    s_add_u32 s77, s72, s3
    buffer_load_dwordx4 v220, s[28:31], s77 offen offset:0  lds
    buffer_load_dwordx4 v221, s[28:31], s77 offen offset:1024  lds
    buffer_load_dwordx4 v222, s[28:31], s77 offen offset:2048  lds
    buffer_load_dwordx4 v223, s[28:31], s77 offen offset:3072  lds
    s_add_u32 m0, s99, 4096
    s_add_u32 s72, s75, 9
    s_cmp_ge_u32 s72, 14
    s_cselect_b32 s77, 14, 0
    s_sub_u32 s72, s72, s77
    s_mul_i32 s72, s72, 131072
    s_add_u32 s77, s72, s3
    buffer_load_dwordx4 v220, s[28:31], s77 offen offset:0  lds
    buffer_load_dwordx4 v221, s[28:31], s77 offen offset:1024  lds
    buffer_load_dwordx4 v222, s[28:31], s77 offen offset:2048  lds
    buffer_load_dwordx4 v223, s[28:31], s77 offen offset:3072  lds
    s_add_u32 m0, s78, 0
    s_add_u32 s72, s75, 10
    s_cmp_ge_u32 s72, 14
    s_cselect_b32 s77, 14, 0
    s_sub_u32 s72, s72, s77
    s_mul_i32 s72, s72, 131072
    s_add_u32 s77, s72, s3
    buffer_load_dwordx4 v220, s[28:31], s77 offen offset:0  lds
    buffer_load_dwordx4 v221, s[28:31], s77 offen offset:1024  lds
    buffer_load_dwordx4 v222, s[28:31], s77 offen offset:2048  lds
    buffer_load_dwordx4 v223, s[28:31], s77 offen offset:3072  lds
    s_add_u32 m0, s78, 4096
    s_add_u32 s72, s75, 11
    s_cmp_ge_u32 s72, 14
    s_cselect_b32 s77, 14, 0
    s_sub_u32 s72, s72, s77
    s_mul_i32 s72, s72, 131072
    s_add_u32 s77, s72, s3
    buffer_load_dwordx4 v220, s[28:31], s77 offen offset:0  lds
    buffer_load_dwordx4 v221, s[28:31], s77 offen offset:1024  lds
    buffer_load_dwordx4 v222, s[28:31], s77 offen offset:2048  lds
    buffer_load_dwordx4 v223, s[28:31], s77 offen offset:3072  lds
    s_add_u32 m0, s78, 8192
    s_add_u32 s72, s75, 12
    s_cmp_ge_u32 s72, 14
    s_cselect_b32 s77, 14, 0
    s_sub_u32 s72, s72, s77
    s_mul_i32 s72, s72, 131072
    s_add_u32 s77, s72, s3
    buffer_load_dwordx4 v220, s[28:31], s77 offen offset:0  lds
    buffer_load_dwordx4 v221, s[28:31], s77 offen offset:1024  lds
    buffer_load_dwordx4 v222, s[28:31], s77 offen offset:2048  lds
    buffer_load_dwordx4 v223, s[28:31], s77 offen offset:3072  lds
    s_add_u32 m0, s78, 12288
    s_add_u32 s72, s75, 13
    s_cmp_ge_u32 s72, 14
    s_cselect_b32 s77, 14, 0
    s_sub_u32 s72, s72, s77
    s_mul_i32 s72, s72, 131072
    s_add_u32 s77, s72, s3
    buffer_load_dwordx4 v220, s[28:31], s77 offen offset:0  lds
    buffer_load_dwordx4 v221, s[28:31], s77 offen offset:1024  lds
    buffer_load_dwordx4 v222, s[28:31], s77 offen offset:2048  lds
    buffer_load_dwordx4 v223, s[28:31], s77 offen offset:3072  lds
    s_waitcnt vmcnt(36)
    ds_read_b64_tr_b16 a[64:65], v2 offset:16384
    ds_read_b64_tr_b16 a[66:67], v2 offset:18432
    ds_read_b64_tr_b16 a[68:69], v3 offset:16384
    ds_read_b64_tr_b16 a[70:71], v3 offset:18432
    ds_read_b64_tr_b16 a[72:73], v4 offset:16384
    ds_read_b64_tr_b16 a[74:75], v4 offset:18432
    ds_read_b64_tr_b16 a[76:77], v5 offset:16384
    ds_read_b64_tr_b16 a[78:79], v5 offset:18432
    s_waitcnt vmcnt(32)
    ds_read_b64_tr_b16 a[80:81], v2 offset:20480
    ds_read_b64_tr_b16 a[82:83], v2 offset:22528
    ds_read_b64_tr_b16 a[84:85], v3 offset:20480
    ds_read_b64_tr_b16 a[86:87], v3 offset:22528
    ds_read_b64_tr_b16 a[88:89], v4 offset:20480
    ds_read_b64_tr_b16 a[90:91], v4 offset:22528
    ds_read_b64_tr_b16 a[92:93], v5 offset:20480
    ds_read_b64_tr_b16 a[94:95], v5 offset:22528
    s_waitcnt lgkmcnt(0)
    s_waitcnt vmcnt(28)
    ds_read_b64_tr_b16 a[96:97], v2 offset:24576
    ds_read_b64_tr_b16 a[98:99], v2 offset:26624
    ds_read_b64_tr_b16 a[100:101], v3 offset:24576
    ds_read_b64_tr_b16 a[102:103], v3 offset:26624
    ds_read_b64_tr_b16 a[104:105], v4 offset:24576
    ds_read_b64_tr_b16 a[106:107], v4 offset:26624
    ds_read_b64_tr_b16 a[108:109], v5 offset:24576
    ds_read_b64_tr_b16 a[110:111], v5 offset:26624
    s_waitcnt vmcnt(24)
    ds_read_b64_tr_b16 a[112:113], v2 offset:28672
    ds_read_b64_tr_b16 a[114:115], v2 offset:30720
    ds_read_b64_tr_b16 a[116:117], v3 offset:28672
    ds_read_b64_tr_b16 a[118:119], v3 offset:30720
    ds_read_b64_tr_b16 a[120:121], v4 offset:28672
    ds_read_b64_tr_b16 a[122:123], v4 offset:30720
    ds_read_b64_tr_b16 a[124:125], v5 offset:28672
    ds_read_b64_tr_b16 a[126:127], v5 offset:30720
    s_waitcnt lgkmcnt(0)
    s_waitcnt vmcnt(20)
    ds_read_b64_tr_b16 a[128:129], v196 offset:0
    ds_read_b64_tr_b16 a[130:131], v196 offset:2048
    ds_read_b64_tr_b16 a[132:133], v197 offset:0
    ds_read_b64_tr_b16 a[134:135], v197 offset:2048
    ds_read_b64_tr_b16 a[136:137], v198 offset:0
    ds_read_b64_tr_b16 a[138:139], v198 offset:2048
    ds_read_b64_tr_b16 a[140:141], v199 offset:0
    ds_read_b64_tr_b16 a[142:143], v199 offset:2048
    s_waitcnt vmcnt(16)
    ds_read_b64_tr_b16 a[144:145], v196 offset:4096
    ds_read_b64_tr_b16 a[146:147], v196 offset:6144
    ds_read_b64_tr_b16 a[148:149], v197 offset:4096
    ds_read_b64_tr_b16 a[150:151], v197 offset:6144
    ds_read_b64_tr_b16 a[152:153], v198 offset:4096
    ds_read_b64_tr_b16 a[154:155], v198 offset:6144
    ds_read_b64_tr_b16 a[156:157], v199 offset:4096
    ds_read_b64_tr_b16 a[158:159], v199 offset:6144
    s_waitcnt lgkmcnt(0)
    s_branch L_pre2
L_nogemm1:
    s_mov_b32 s32, s18
    s_and_b32 s33, s19, 0xffff
    s_mov_b32 s34, 2621440
    s_mov_b32 s35, 0x20000
    s_add_u32 s44, s18, 6291456
    s_addc_u32 s45, s19, 0
    s_and_b32 s45, s45, 0xffff
    s_mov_b32 s46, 262144
    s_mov_b32 s47, 0x20000
    s_mov_b32 s48, s8
    s_and_b32 s49, s9, 0xffff
    s_mov_b32 s50, 3456
    s_mov_b32 s51, 0x20000
    s_mov_b32 s28, s10
    s_and_b32 s29, s11, 0xffff
    s_mov_b32 s30, 7077888
    s_mov_b32 s31, 0x20000
    s_mov_b32 s52, s12
    s_and_b32 s53, s13, 0xffff
    s_mov_b32 s54, 4096
    s_mov_b32 s55, 0x20000
    s_mov_b32 s40, s14
    s_and_b32 s41, s15, 0xffff
    s_mov_b32 s42, 2621440
    s_mov_b32 s43, 0x20000
    s_add_u32 s36, s18, 3145728
    s_addc_u32 s37, s19, 0
    s_and_b32 s37, s37, 0xffff
    s_mov_b32 s38, 2211840
    s_mov_b32 s39, 0x20000
    v_lshrrev_b32 v15, 4, v1
    v_lshlrev_b32 v15, 3, v15
    s_and_b32 s68, s60, 1
    s_lshl_b32 s68, s68, 6
    s_lshl_b32 s69, s63, 7
    s_add_u32 s68, s68, s69
    buffer_load_dwordx2 v[10:11], v15, s[48:51], s68 offen
    buffer_load_dwordx2 v[12:13], v15, s[48:51], s68 offen offset:32
    v_and_b32 v15, 15, v1
    v_lshlrev_b32 v15, 1, v15
    s_lshl_b32 s68, s65, 7
    s_lshl_b32 s69, s60, 5
    s_add_u32 s68, s68, s69
    buffer_load_ushort v14, v15, s[52:55], s68 offen
    v_lshrrev_b32 v15, 3, v1
    v_lshrrev_b32 v9, 1, v15
    v_lshlrev_b32 v9, 1, v9
    v_and_b32 v220, 7, v1
    v_xor_b32 v220, v220, v9
    v_lshlrev_b32 v220, 4, v220
    v_mul_u32_u24 v15, 4096, v15
    v_add_u32 v220, v220, v15
    s_lshl_b32 s68, s65, 7
    v_add_u32 v220, s68, v220
    v_add_u32 v221, 31744, v220
    v_add_u32 v222, 63488, v220
    v_add_u32 v223, 95232, v220
    s_mul_i32 s3, s60, 1835008
    v_lshrrev_b32 v216, 4, v1
    v_and_b32 v217, 1, v216
    v_lshlrev_b32 v217, 2, v217
    v_bfe_u32 v218, v1, 2, 2
    v_add_u32 v217, v217, v218
    v_lshrrev_b32 v216, 1, v216
    v_lshlrev_b32 v216, 10, v216
    v_lshlrev_b32 v218, 7, v217
    v_add_u32 v216, v216, v218
    v_and_b32 v218, 3, v1
    v_lshlrev_b32 v218, 3, v218
    v_add_u32 v216, v216, v218
    v_add_u32 v216, s78, v216
    v_lshrrev_b32 v217, 1, v217
    v_xor_b32 v218, 0, v217
    v_lshlrev_b32 v218, 5, v218
    v_add_u32 v2, v216, v218
    v_xor_b32 v218, 1, v217
    v_lshlrev_b32 v218, 5, v218
    v_add_u32 v3, v216, v218
    v_xor_b32 v218, 2, v217
    v_lshlrev_b32 v218, 5, v218
    v_add_u32 v4, v216, v218
    v_xor_b32 v218, 3, v217
    v_lshlrev_b32 v218, 5, v218
    v_add_u32 v5, v216, v218
    s_sub_u32 s68, s99, s78
    v_add_u32 v196, s68, v2
    v_add_u32 v197, s68, v3
    v_add_u32 v198, s68, v4
    v_add_u32 v199, s68, v5
    v_lshlrev_b32 v200, 4, v1
    v_add_u32 v201, 65536, v200
    v_add_u32 v202, 131072, v200
    s_add_u32 m0, s78, 0
    s_add_u32 s72, s75, 0
    s_cmp_ge_u32 s72, 14
    s_cselect_b32 s77, 14, 0
    s_sub_u32 s72, s72, s77
    s_mul_i32 s72, s72, 131072
    s_add_u32 s77, s72, s3
    buffer_load_dwordx4 v220, s[28:31], s77 offen offset:0  lds
    buffer_load_dwordx4 v221, s[28:31], s77 offen offset:1024  lds
    buffer_load_dwordx4 v222, s[28:31], s77 offen offset:2048  lds
    buffer_load_dwordx4 v223, s[28:31], s77 offen offset:3072  lds
    s_add_u32 m0, s78, 4096
    s_add_u32 s72, s75, 1
    s_cmp_ge_u32 s72, 14
    s_cselect_b32 s77, 14, 0
    s_sub_u32 s72, s72, s77
    s_mul_i32 s72, s72, 131072
    s_add_u32 s77, s72, s3
    buffer_load_dwordx4 v220, s[28:31], s77 offen offset:0  lds
    buffer_load_dwordx4 v221, s[28:31], s77 offen offset:1024  lds
    buffer_load_dwordx4 v222, s[28:31], s77 offen offset:2048  lds
    buffer_load_dwordx4 v223, s[28:31], s77 offen offset:3072  lds
    s_add_u32 m0, s78, 8192
    s_add_u32 s72, s75, 2
    s_cmp_ge_u32 s72, 14
    s_cselect_b32 s77, 14, 0
    s_sub_u32 s72, s72, s77
    s_mul_i32 s72, s72, 131072
    s_add_u32 s77, s72, s3
    buffer_load_dwordx4 v220, s[28:31], s77 offen offset:0  lds
    buffer_load_dwordx4 v221, s[28:31], s77 offen offset:1024  lds
    buffer_load_dwordx4 v222, s[28:31], s77 offen offset:2048  lds
    buffer_load_dwordx4 v223, s[28:31], s77 offen offset:3072  lds
    s_add_u32 m0, s78, 12288
    s_add_u32 s72, s75, 3
    s_cmp_ge_u32 s72, 14
    s_cselect_b32 s77, 14, 0
    s_sub_u32 s72, s72, s77
    s_mul_i32 s72, s72, 131072
    s_add_u32 s77, s72, s3
    buffer_load_dwordx4 v220, s[28:31], s77 offen offset:0  lds
    buffer_load_dwordx4 v221, s[28:31], s77 offen offset:1024  lds
    buffer_load_dwordx4 v222, s[28:31], s77 offen offset:2048  lds
    buffer_load_dwordx4 v223, s[28:31], s77 offen offset:3072  lds
    s_add_u32 m0, s78, 16384
    s_add_u32 s72, s75, 4
    s_cmp_ge_u32 s72, 14
    s_cselect_b32 s77, 14, 0
    s_sub_u32 s72, s72, s77
    s_mul_i32 s72, s72, 131072
    s_add_u32 s77, s72, s3
    buffer_load_dwordx4 v220, s[28:31], s77 offen offset:0  lds
    buffer_load_dwordx4 v221, s[28:31], s77 offen offset:1024  lds
    buffer_load_dwordx4 v222, s[28:31], s77 offen offset:2048  lds
    buffer_load_dwordx4 v223, s[28:31], s77 offen offset:3072  lds
    s_add_u32 m0, s78, 20480
    s_add_u32 s72, s75, 5
    s_cmp_ge_u32 s72, 14
    s_cselect_b32 s77, 14, 0
    s_sub_u32 s72, s72, s77
    s_mul_i32 s72, s72, 131072
    s_add_u32 s77, s72, s3
    buffer_load_dwordx4 v220, s[28:31], s77 offen offset:0  lds
    buffer_load_dwordx4 v221, s[28:31], s77 offen offset:1024  lds
    buffer_load_dwordx4 v222, s[28:31], s77 offen offset:2048  lds
    buffer_load_dwordx4 v223, s[28:31], s77 offen offset:3072  lds
    s_add_u32 m0, s78, 24576
    s_add_u32 s72, s75, 6
    s_cmp_ge_u32 s72, 14
    s_cselect_b32 s77, 14, 0
    s_sub_u32 s72, s72, s77
    s_mul_i32 s72, s72, 131072
    s_add_u32 s77, s72, s3
    buffer_load_dwordx4 v220, s[28:31], s77 offen offset:0  lds
    buffer_load_dwordx4 v221, s[28:31], s77 offen offset:1024  lds
    buffer_load_dwordx4 v222, s[28:31], s77 offen offset:2048  lds
    buffer_load_dwordx4 v223, s[28:31], s77 offen offset:3072  lds
    s_add_u32 m0, s78, 28672
    s_add_u32 s72, s75, 7
    s_cmp_ge_u32 s72, 14
    s_cselect_b32 s77, 14, 0
    s_sub_u32 s72, s72, s77
    s_mul_i32 s72, s72, 131072
    s_add_u32 s77, s72, s3
    buffer_load_dwordx4 v220, s[28:31], s77 offen offset:0  lds
    buffer_load_dwordx4 v221, s[28:31], s77 offen offset:1024  lds
    buffer_load_dwordx4 v222, s[28:31], s77 offen offset:2048  lds
    buffer_load_dwordx4 v223, s[28:31], s77 offen offset:3072  lds
    s_add_u32 m0, s99, 0
    s_add_u32 s72, s75, 8
    s_cmp_ge_u32 s72, 14
    s_cselect_b32 s77, 14, 0
    s_sub_u32 s72, s72, s77
    s_mul_i32 s72, s72, 131072
    s_add_u32 s77, s72, s3
    buffer_load_dwordx4 v220, s[28:31], s77 offen offset:0  lds
    buffer_load_dwordx4 v221, s[28:31], s77 offen offset:1024  lds
    buffer_load_dwordx4 v222, s[28:31], s77 offen offset:2048  lds
    buffer_load_dwordx4 v223, s[28:31], s77 offen offset:3072  lds
    s_add_u32 m0, s99, 4096
    s_add_u32 s72, s75, 9
    s_cmp_ge_u32 s72, 14
    s_cselect_b32 s77, 14, 0
    s_sub_u32 s72, s72, s77
    s_mul_i32 s72, s72, 131072
    s_add_u32 s77, s72, s3
    buffer_load_dwordx4 v220, s[28:31], s77 offen offset:0  lds
    buffer_load_dwordx4 v221, s[28:31], s77 offen offset:1024  lds
    buffer_load_dwordx4 v222, s[28:31], s77 offen offset:2048  lds
    buffer_load_dwordx4 v223, s[28:31], s77 offen offset:3072  lds
    s_waitcnt vmcnt(36)
    ds_read_b64_tr_b16 a[0:1], v2 offset:0
    ds_read_b64_tr_b16 a[2:3], v2 offset:2048
    ds_read_b64_tr_b16 a[4:5], v3 offset:0
    ds_read_b64_tr_b16 a[6:7], v3 offset:2048
    ds_read_b64_tr_b16 a[8:9], v4 offset:0
    ds_read_b64_tr_b16 a[10:11], v4 offset:2048
    ds_read_b64_tr_b16 a[12:13], v5 offset:0
    ds_read_b64_tr_b16 a[14:15], v5 offset:2048
    s_waitcnt vmcnt(32)
    ds_read_b64_tr_b16 a[16:17], v2 offset:4096
    ds_read_b64_tr_b16 a[18:19], v2 offset:6144
    ds_read_b64_tr_b16 a[20:21], v3 offset:4096
    ds_read_b64_tr_b16 a[22:23], v3 offset:6144
    ds_read_b64_tr_b16 a[24:25], v4 offset:4096
    ds_read_b64_tr_b16 a[26:27], v4 offset:6144
    ds_read_b64_tr_b16 a[28:29], v5 offset:4096
    ds_read_b64_tr_b16 a[30:31], v5 offset:6144
    s_waitcnt lgkmcnt(0)
    s_waitcnt vmcnt(28)
    ds_read_b64_tr_b16 a[32:33], v2 offset:8192
    ds_read_b64_tr_b16 a[34:35], v2 offset:10240
    ds_read_b64_tr_b16 a[36:37], v3 offset:8192
    ds_read_b64_tr_b16 a[38:39], v3 offset:10240
    ds_read_b64_tr_b16 a[40:41], v4 offset:8192
    ds_read_b64_tr_b16 a[42:43], v4 offset:10240
    ds_read_b64_tr_b16 a[44:45], v5 offset:8192
    ds_read_b64_tr_b16 a[46:47], v5 offset:10240
    s_waitcnt vmcnt(24)
    ds_read_b64_tr_b16 a[48:49], v2 offset:12288
    ds_read_b64_tr_b16 a[50:51], v2 offset:14336
    ds_read_b64_tr_b16 a[52:53], v3 offset:12288
    ds_read_b64_tr_b16 a[54:55], v3 offset:14336
    ds_read_b64_tr_b16 a[56:57], v4 offset:12288
    ds_read_b64_tr_b16 a[58:59], v4 offset:14336
    ds_read_b64_tr_b16 a[60:61], v5 offset:12288
    ds_read_b64_tr_b16 a[62:63], v5 offset:14336
    s_waitcnt lgkmcnt(0)
    s_add_u32 m0, s78, 0
    s_add_u32 s72, s75, 10
    s_cmp_ge_u32 s72, 14
    s_cselect_b32 s77, 14, 0
    s_sub_u32 s72, s72, s77
    s_mul_i32 s72, s72, 131072
    s_add_u32 s77, s72, s3
    buffer_load_dwordx4 v220, s[28:31], s77 offen offset:0  lds
    buffer_load_dwordx4 v221, s[28:31], s77 offen offset:1024  lds
    buffer_load_dwordx4 v222, s[28:31], s77 offen offset:2048  lds
    buffer_load_dwordx4 v223, s[28:31], s77 offen offset:3072  lds
    s_add_u32 m0, s78, 4096
    s_add_u32 s72, s75, 11
    s_cmp_ge_u32 s72, 14
    s_cselect_b32 s77, 14, 0
    s_sub_u32 s72, s72, s77
    s_mul_i32 s72, s72, 131072
    s_add_u32 s77, s72, s3
    buffer_load_dwordx4 v220, s[28:31], s77 offen offset:0  lds
    buffer_load_dwordx4 v221, s[28:31], s77 offen offset:1024  lds
    buffer_load_dwordx4 v222, s[28:31], s77 offen offset:2048  lds
    buffer_load_dwordx4 v223, s[28:31], s77 offen offset:3072  lds
    s_add_u32 m0, s78, 8192
    s_add_u32 s72, s75, 12
    s_cmp_ge_u32 s72, 14
    s_cselect_b32 s77, 14, 0
    s_sub_u32 s72, s72, s77
    s_mul_i32 s72, s72, 131072
    s_add_u32 s77, s72, s3
    buffer_load_dwordx4 v220, s[28:31], s77 offen offset:0  lds
    buffer_load_dwordx4 v221, s[28:31], s77 offen offset:1024  lds
    buffer_load_dwordx4 v222, s[28:31], s77 offen offset:2048  lds
    buffer_load_dwordx4 v223, s[28:31], s77 offen offset:3072  lds
    s_add_u32 m0, s78, 12288
    s_add_u32 s72, s75, 13
    s_cmp_ge_u32 s72, 14
    s_cselect_b32 s77, 14, 0
    s_sub_u32 s72, s72, s77
    s_mul_i32 s72, s72, 131072
    s_add_u32 s77, s72, s3
    buffer_load_dwordx4 v220, s[28:31], s77 offen offset:0  lds
    buffer_load_dwordx4 v221, s[28:31], s77 offen offset:1024  lds
    buffer_load_dwordx4 v222, s[28:31], s77 offen offset:2048  lds
    buffer_load_dwordx4 v223, s[28:31], s77 offen offset:3072  lds
    s_waitcnt vmcnt(36)
    ds_read_b64_tr_b16 a[64:65], v2 offset:16384
    ds_read_b64_tr_b16 a[66:67], v2 offset:18432
    ds_read_b64_tr_b16 a[68:69], v3 offset:16384
    ds_read_b64_tr_b16 a[70:71], v3 offset:18432
    ds_read_b64_tr_b16 a[72:73], v4 offset:16384
    ds_read_b64_tr_b16 a[74:75], v4 offset:18432
    ds_read_b64_tr_b16 a[76:77], v5 offset:16384
    ds_read_b64_tr_b16 a[78:79], v5 offset:18432
    s_waitcnt vmcnt(32)
    ds_read_b64_tr_b16 a[80:81], v2 offset:20480
    ds_read_b64_tr_b16 a[82:83], v2 offset:22528
    ds_read_b64_tr_b16 a[84:85], v3 offset:20480
    ds_read_b64_tr_b16 a[86:87], v3 offset:22528
    ds_read_b64_tr_b16 a[88:89], v4 offset:20480
    ds_read_b64_tr_b16 a[90:91], v4 offset:22528
    ds_read_b64_tr_b16 a[92:93], v5 offset:20480
    ds_read_b64_tr_b16 a[94:95], v5 offset:22528
    s_waitcnt lgkmcnt(0)
    s_waitcnt vmcnt(28)
    ds_read_b64_tr_b16 a[96:97], v2 offset:24576
    ds_read_b64_tr_b16 a[98:99], v2 offset:26624
    ds_read_b64_tr_b16 a[100:101], v3 offset:24576
    ds_read_b64_tr_b16 a[102:103], v3 offset:26624
    ds_read_b64_tr_b16 a[104:105], v4 offset:24576
    ds_read_b64_tr_b16 a[106:107], v4 offset:26624
    ds_read_b64_tr_b16 a[108:109], v5 offset:24576
    ds_read_b64_tr_b16 a[110:111], v5 offset:26624
    s_waitcnt vmcnt(24)
    ds_read_b64_tr_b16 a[112:113], v2 offset:28672
    ds_read_b64_tr_b16 a[114:115], v2 offset:30720
    ds_read_b64_tr_b16 a[116:117], v3 offset:28672
    ds_read_b64_tr_b16 a[118:119], v3 offset:30720
    ds_read_b64_tr_b16 a[120:121], v4 offset:28672
    ds_read_b64_tr_b16 a[122:123], v4 offset:30720
    ds_read_b64_tr_b16 a[124:125], v5 offset:28672
    ds_read_b64_tr_b16 a[126:127], v5 offset:30720
    s_waitcnt lgkmcnt(0)
    s_waitcnt vmcnt(20)
    ds_read_b64_tr_b16 a[128:129], v196 offset:0
    ds_read_b64_tr_b16 a[130:131], v196 offset:2048
    ds_read_b64_tr_b16 a[132:133], v197 offset:0
    ds_read_b64_tr_b16 a[134:135], v197 offset:2048
    ds_read_b64_tr_b16 a[136:137], v198 offset:0
    ds_read_b64_tr_b16 a[138:139], v198 offset:2048
    ds_read_b64_tr_b16 a[140:141], v199 offset:0
    ds_read_b64_tr_b16 a[142:143], v199 offset:2048
    s_waitcnt vmcnt(16)
    ds_read_b64_tr_b16 a[144:145], v196 offset:4096
    ds_read_b64_tr_b16 a[146:147], v196 offset:6144
    ds_read_b64_tr_b16 a[148:149], v197 offset:4096
    ds_read_b64_tr_b16 a[150:151], v197 offset:6144
    ds_read_b64_tr_b16 a[152:153], v198 offset:4096
    ds_read_b64_tr_b16 a[154:155], v198 offset:6144
    ds_read_b64_tr_b16 a[156:157], v199 offset:4096
    ds_read_b64_tr_b16 a[158:159], v199 offset:6144
    s_waitcnt lgkmcnt(0)
L_pre2:
    s_mul_i32 s68, s66, 5120
    v_add_u32 v6, s68, v200
    v_add_u32 v7, 4096, v6
    s_cmp_lg_u32 s60, 3
    s_cbranch_scc1 L_gpolled
    s_lshl_b32 s68, s66, 5
    s_mul_i32 s68, s68, 256
    s_add_u32 s68, s68, 65536
    v_mul_u32_u24 v216, 256, v1
    v_add_u32 v216, s68, v216
    s_mov_b32 s82, 0x7ffffff
    s_mov_b32 s83, 0
    s_mov_b32 s79, 0
L_poll_5:
    buffer_load_dword v228, v216, s[44:47], 0 offen offset:0 sc1
    s_waitcnt vmcnt(0)
    v_cmp_ne_u32 vcc, s67, v228
    s_and_b64 vcc, vcc, s[82:83]
    s_add_u32 s79, s79, 1
    s_cmp_eq_u64 vcc, 0
    s_cbranch_scc1 L_polled_6
    s_sleep 8
    s_cmp_lt_u32 s79, 20000
    s_cbranch_scc1 L_poll_5
L_polled_6:
L_gpolled:
    s_barrier
    s_mul_i32 s76, s60, 573440
    s_add_u32 s72, s75, 0
    s_cmp_ge_u32 s72, 14
    s_cselect_b32 s77, 14, 0
    s_sub_u32 s72, s72, s77
    s_mul_i32 s72, s72, 40960
    s_add_u32 s77, s72, s76
    buffer_load_dwordx4 v[96:99], v6, s[36:39], s77 offen offset:0 sc1
    buffer_load_dwordx4 v[100:103], v6, s[36:39], s77 offen offset:1024 sc1
    buffer_load_dwordx4 v[104:107], v6, s[36:39], s77 offen offset:2048 sc1
    buffer_load_dwordx4 v[108:111], v6, s[36:39], s77 offen offset:3072 sc1
    buffer_load_dwordx4 v[112:115], v7, s[36:39], s77 offen offset:0 sc1
    s_add_u32 s72, s75, 1
    s_cmp_ge_u32 s72, 14
    s_cselect_b32 s77, 14, 0
    s_sub_u32 s72, s72, s77
    s_mul_i32 s72, s72, 40960
    s_add_u32 s77, s72, s76
    buffer_load_dwordx4 v[116:119], v6, s[36:39], s77 offen offset:0 sc1
    buffer_load_dwordx4 v[120:123], v6, s[36:39], s77 offen offset:1024 sc1
    buffer_load_dwordx4 v[124:127], v6, s[36:39], s77 offen offset:2048 sc1
    buffer_load_dwordx4 v[128:131], v6, s[36:39], s77 offen offset:3072 sc1
    buffer_load_dwordx4 v[132:135], v7, s[36:39], s77 offen offset:0 sc1
    s_add_u32 s72, s75, 2
    s_cmp_ge_u32 s72, 14
    s_cselect_b32 s77, 14, 0
    s_sub_u32 s72, s72, s77
    s_mul_i32 s72, s72, 40960
    s_add_u32 s77, s72, s76
    buffer_load_dwordx4 v[136:139], v6, s[36:39], s77 offen offset:0 sc1
    buffer_load_dwordx4 v[140:143], v6, s[36:39], s77 offen offset:1024 sc1
    s_waitcnt vmcnt(12)
    s_waitcnt lgkmcnt(0)
    ds_read_b64_tr_b16 a[160:161], v2 offset:0
    ds_read_b64_tr_b16 a[162:163], v2 offset:2048
    ds_read_b64_tr_b16 a[164:165], v3 offset:0
    ds_read_b64_tr_b16 a[166:167], v3 offset:2048
    ds_read_b64_tr_b16 a[168:169], v4 offset:0
    ds_read_b64_tr_b16 a[170:171], v4 offset:2048
    ds_read_b64_tr_b16 a[172:173], v5 offset:0
    ds_read_b64_tr_b16 a[174:175], v5 offset:2048
    ds_read_b64_tr_b16 a[176:177], v2 offset:4096
    ds_read_b64_tr_b16 a[178:179], v2 offset:6144
    ds_read_b64_tr_b16 a[180:181], v3 offset:4096
    ds_read_b64_tr_b16 a[182:183], v3 offset:6144
    ds_read_b64_tr_b16 a[184:185], v4 offset:4096
    ds_read_b64_tr_b16 a[186:187], v4 offset:6144
    ds_read_b64_tr_b16 a[188:189], v5 offset:4096
    ds_read_b64_tr_b16 a[190:191], v5 offset:6144
    s_waitcnt lgkmcnt(0)
    ds_read_b64_tr_b16 a[192:193], v2 offset:8192
    ds_read_b64_tr_b16 a[194:195], v2 offset:10240
    ds_read_b64_tr_b16 a[196:197], v3 offset:8192
    ds_read_b64_tr_b16 a[198:199], v3 offset:10240
    ds_read_b64_tr_b16 a[200:201], v4 offset:8192
    ds_read_b64_tr_b16 a[202:203], v4 offset:10240
    ds_read_b64_tr_b16 a[204:205], v5 offset:8192
    ds_read_b64_tr_b16 a[206:207], v5 offset:10240
    ds_read_b64_tr_b16 a[208:209], v2 offset:12288
    ds_read_b64_tr_b16 a[210:211], v2 offset:14336
    ds_read_b64_tr_b16 a[212:213], v3 offset:12288
    ds_read_b64_tr_b16 a[214:215], v3 offset:14336
    ds_read_b64_tr_b16 a[216:217], v4 offset:12288
    ds_read_b64_tr_b16 a[218:219], v4 offset:14336
    ds_read_b64_tr_b16 a[220:221], v5 offset:12288
    ds_read_b64_tr_b16 a[222:223], v5 offset:14336
    s_waitcnt lgkmcnt(0)
    s_waitcnt vmcnt(11)
    buffer_load_dwordx4 v[144:147], v6, s[36:39], s77 offen offset:2048 sc1
    v_mfma_f32_16x16x32_bf16 v[16:19], v[96:99], a[0:3], 0
    v_mfma_f32_16x16x32_bf16 v[20:23], v[96:99], a[4:7], 0
    v_mfma_f32_16x16x32_bf16 v[24:27], v[96:99], a[8:11], 0
    v_mfma_f32_16x16x32_bf16 v[28:31], v[96:99], a[12:15], 0
    s_waitcnt vmcnt(11)
    buffer_load_dwordx4 v[148:151], v6, s[36:39], s77 offen offset:3072 sc1
    v_mfma_f32_16x16x32_bf16 v[32:35], v[100:103], a[0:3], 0
    v_mfma_f32_16x16x32_bf16 v[36:39], v[100:103], a[4:7], 0
    v_mfma_f32_16x16x32_bf16 v[40:43], v[100:103], a[8:11], 0
    v_mfma_f32_16x16x32_bf16 v[44:47], v[100:103], a[12:15], 0
    s_waitcnt vmcnt(11)
    buffer_load_dwordx4 v[152:155], v7, s[36:39], s77 offen offset:0 sc1
    v_mfma_f32_16x16x32_bf16 v[48:51], v[104:107], a[0:3], 0
    v_mfma_f32_16x16x32_bf16 v[52:55], v[104:107], a[4:7], 0
    v_mfma_f32_16x16x32_bf16 v[56:59], v[104:107], a[8:11], 0
    v_mfma_f32_16x16x32_bf16 v[60:63], v[104:107], a[12:15], 0
    s_waitcnt vmcnt(11)
    s_add_u32 s72, s75, 3
    s_cmp_ge_u32 s72, 14
    s_cselect_b32 s77, 14, 0
    s_sub_u32 s72, s72, s77
    s_mul_i32 s72, s72, 40960
    s_add_u32 s77, s72, s76
    buffer_load_dwordx4 v[96:99], v6, s[36:39], s77 offen offset:0 sc1
    v_mfma_f32_16x16x32_bf16 v[64:67], v[108:111], a[0:3], 0
    v_mfma_f32_16x16x32_bf16 v[68:71], v[108:111], a[4:7], 0
    v_mfma_f32_16x16x32_bf16 v[72:75], v[108:111], a[8:11], 0
    v_mfma_f32_16x16x32_bf16 v[76:79], v[108:111], a[12:15], 0
    s_waitcnt vmcnt(11)
    buffer_load_dwordx4 v[100:103], v6, s[36:39], s77 offen offset:1024 sc1
    v_mfma_f32_16x16x32_bf16 v[80:83], v[112:115], a[0:3], 0
    v_mfma_f32_16x16x32_bf16 v[84:87], v[112:115], a[4:7], 0
    v_mfma_f32_16x16x32_bf16 v[88:91], v[112:115], a[8:11], 0
    v_mfma_f32_16x16x32_bf16 v[92:95], v[112:115], a[12:15], 0
    s_waitcnt vmcnt(11)
    buffer_load_dwordx4 v[104:107], v6, s[36:39], s77 offen offset:2048 sc1
    v_mfma_f32_16x16x32_bf16 v[16:19], v[116:119], a[16:19], v[16:19]
    v_mfma_f32_16x16x32_bf16 v[20:23], v[116:119], a[20:23], v[20:23]
    v_mfma_f32_16x16x32_bf16 v[24:27], v[116:119], a[24:27], v[24:27]
    v_mfma_f32_16x16x32_bf16 v[28:31], v[116:119], a[28:31], v[28:31]
    s_waitcnt vmcnt(11)
    buffer_load_dwordx4 v[108:111], v6, s[36:39], s77 offen offset:3072 sc1
    v_mfma_f32_16x16x32_bf16 v[32:35], v[120:123], a[16:19], v[32:35]
    v_mfma_f32_16x16x32_bf16 v[36:39], v[120:123], a[20:23], v[36:39]
    v_mfma_f32_16x16x32_bf16 v[40:43], v[120:123], a[24:27], v[40:43]
    v_mfma_f32_16x16x32_bf16 v[44:47], v[120:123], a[28:31], v[44:47]
    s_waitcnt vmcnt(11)
    buffer_load_dwordx4 v[112:115], v7, s[36:39], s77 offen offset:0 sc1
    v_mfma_f32_16x16x32_bf16 v[48:51], v[124:127], a[16:19], v[48:51]
    v_mfma_f32_16x16x32_bf16 v[52:55], v[124:127], a[20:23], v[52:55]
    v_mfma_f32_16x16x32_bf16 v[56:59], v[124:127], a[24:27], v[56:59]
    v_mfma_f32_16x16x32_bf16 v[60:63], v[124:127], a[28:31], v[60:63]
    s_waitcnt vmcnt(11)
    s_add_u32 s72, s75, 4
    s_cmp_ge_u32 s72, 14
    s_cselect_b32 s77, 14, 0
    s_sub_u32 s72, s72, s77
    s_mul_i32 s72, s72, 40960
    s_add_u32 s77, s72, s76
    buffer_load_dwordx4 v[116:119], v6, s[36:39], s77 offen offset:0 sc1
    v_mfma_f32_16x16x32_bf16 v[64:67], v[128:131], a[16:19], v[64:67]
    v_mfma_f32_16x16x32_bf16 v[68:71], v[128:131], a[20:23], v[68:71]
    v_mfma_f32_16x16x32_bf16 v[72:75], v[128:131], a[24:27], v[72:75]
    v_mfma_f32_16x16x32_bf16 v[76:79], v[128:131], a[28:31], v[76:79]
    s_waitcnt vmcnt(11)
    buffer_load_dwordx4 v[120:123], v6, s[36:39], s77 offen offset:1024 sc1
    v_mfma_f32_16x16x32_bf16 v[80:83], v[132:135], a[16:19], v[80:83]
    v_mfma_f32_16x16x32_bf16 v[84:87], v[132:135], a[20:23], v[84:87]
    v_mfma_f32_16x16x32_bf16 v[88:91], v[132:135], a[24:27], v[88:91]
    v_mfma_f32_16x16x32_bf16 v[92:95], v[132:135], a[28:31], v[92:95]
    s_waitcnt vmcnt(11)
    buffer_load_dwordx4 v[124:127], v6, s[36:39], s77 offen offset:2048 sc1
    v_mfma_f32_16x16x32_bf16 v[16:19], v[136:139], a[32:35], v[16:19]
    v_mfma_f32_16x16x32_bf16 v[20:23], v[136:139], a[36:39], v[20:23]
    v_mfma_f32_16x16x32_bf16 v[24:27], v[136:139], a[40:43], v[24:27]
    v_mfma_f32_16x16x32_bf16 v[28:31], v[136:139], a[44:47], v[28:31]
    s_waitcnt vmcnt(11)
    buffer_load_dwordx4 v[128:131], v6, s[36:39], s77 offen offset:3072 sc1
    v_mfma_f32_16x16x32_bf16 v[32:35], v[140:143], a[32:35], v[32:35]
    v_mfma_f32_16x16x32_bf16 v[36:39], v[140:143], a[36:39], v[36:39]
    v_mfma_f32_16x16x32_bf16 v[40:43], v[140:143], a[40:43], v[40:43]
    v_mfma_f32_16x16x32_bf16 v[44:47], v[140:143], a[44:47], v[44:47]
    s_waitcnt vmcnt(11)
    buffer_load_dwordx4 v[132:135], v7, s[36:39], s77 offen offset:0 sc1
    v_mfma_f32_16x16x32_bf16 v[48:51], v[144:147], a[32:35], v[48:51]
    v_mfma_f32_16x16x32_bf16 v[52:55], v[144:147], a[36:39], v[52:55]
    v_mfma_f32_16x16x32_bf16 v[56:59], v[144:147], a[40:43], v[56:59]
    v_mfma_f32_16x16x32_bf16 v[60:63], v[144:147], a[44:47], v[60:63]
    s_waitcnt vmcnt(11)
    s_add_u32 s72, s75, 5
    s_cmp_ge_u32 s72, 14
    s_cselect_b32 s77, 14, 0
    s_sub_u32 s72, s72, s77
    s_mul_i32 s72, s72, 40960
    s_add_u32 s77, s72, s76
    buffer_load_dwordx4 v[136:139], v6, s[36:39], s77 offen offset:0 sc1
    v_mfma_f32_16x16x32_bf16 v[64:67], v[148:151], a[32:35], v[64:67]
    v_mfma_f32_16x16x32_bf16 v[68:71], v[148:151], a[36:39], v[68:71]
    v_mfma_f32_16x16x32_bf16 v[72:75], v[148:151], a[40:43], v[72:75]
    v_mfma_f32_16x16x32_bf16 v[76:79], v[148:151], a[44:47], v[76:79]
    s_waitcnt vmcnt(11)
    buffer_load_dwordx4 v[140:143], v6, s[36:39], s77 offen offset:1024 sc1
    v_mfma_f32_16x16x32_bf16 v[80:83], v[152:155], a[32:35], v[80:83]
    v_mfma_f32_16x16x32_bf16 v[84:87], v[152:155], a[36:39], v[84:87]
    v_mfma_f32_16x16x32_bf16 v[88:91], v[152:155], a[40:43], v[88:91]
    v_mfma_f32_16x16x32_bf16 v[92:95], v[152:155], a[44:47], v[92:95]
    s_waitcnt vmcnt(11)
    buffer_load_dwordx4 v[144:147], v6, s[36:39], s77 offen offset:2048 sc1
    v_mfma_f32_16x16x32_bf16 v[16:19], v[96:99], a[48:51], v[16:19]
    v_mfma_f32_16x16x32_bf16 v[20:23], v[96:99], a[52:55], v[20:23]
    v_mfma_f32_16x16x32_bf16 v[24:27], v[96:99], a[56:59], v[24:27]
    v_mfma_f32_16x16x32_bf16 v[28:31], v[96:99], a[60:63], v[28:31]
    s_waitcnt vmcnt(11)
    buffer_load_dwordx4 v[148:151], v6, s[36:39], s77 offen offset:3072 sc1
    v_mfma_f32_16x16x32_bf16 v[32:35], v[100:103], a[48:51], v[32:35]
    v_mfma_f32_16x16x32_bf16 v[36:39], v[100:103], a[52:55], v[36:39]
    v_mfma_f32_16x16x32_bf16 v[40:43], v[100:103], a[56:59], v[40:43]
    v_mfma_f32_16x16x32_bf16 v[44:47], v[100:103], a[60:63], v[44:47]
    s_waitcnt vmcnt(11)
    buffer_load_dwordx4 v[152:155], v7, s[36:39], s77 offen offset:0 sc1
    v_mfma_f32_16x16x32_bf16 v[48:51], v[104:107], a[48:51], v[48:51]
    v_mfma_f32_16x16x32_bf16 v[52:55], v[104:107], a[52:55], v[52:55]
    v_mfma_f32_16x16x32_bf16 v[56:59], v[104:107], a[56:59], v[56:59]
    v_mfma_f32_16x16x32_bf16 v[60:63], v[104:107], a[60:63], v[60:63]
    s_waitcnt vmcnt(11)
    s_add_u32 s72, s75, 6
    s_cmp_ge_u32 s72, 14
    s_cselect_b32 s77, 14, 0
    s_sub_u32 s72, s72, s77
    s_mul_i32 s72, s72, 40960
    s_add_u32 s77, s72, s76
    buffer_load_dwordx4 v[96:99], v6, s[36:39], s77 offen offset:0 sc1
    v_mfma_f32_16x16x32_bf16 v[64:67], v[108:111], a[48:51], v[64:67]
    v_mfma_f32_16x16x32_bf16 v[68:71], v[108:111], a[52:55], v[68:71]
    v_mfma_f32_16x16x32_bf16 v[72:75], v[108:111], a[56:59], v[72:75]
    v_mfma_f32_16x16x32_bf16 v[76:79], v[108:111], a[60:63], v[76:79]
    s_waitcnt vmcnt(11)
    buffer_load_dwordx4 v[100:103], v6, s[36:39], s77 offen offset:1024 sc1
    v_mfma_f32_16x16x32_bf16 v[80:83], v[112:115], a[48:51], v[80:83]
    v_mfma_f32_16x16x32_bf16 v[84:87], v[112:115], a[52:55], v[84:87]
    v_mfma_f32_16x16x32_bf16 v[88:91], v[112:115], a[56:59], v[88:91]
    v_mfma_f32_16x16x32_bf16 v[92:95], v[112:115], a[60:63], v[92:95]
    s_waitcnt vmcnt(11)
    buffer_load_dwordx4 v[104:107], v6, s[36:39], s77 offen offset:2048 sc1
    v_mfma_f32_16x16x32_bf16 v[16:19], v[116:119], a[64:67], v[16:19]
    v_mfma_f32_16x16x32_bf16 v[20:23], v[116:119], a[68:71], v[20:23]
    v_mfma_f32_16x16x32_bf16 v[24:27], v[116:119], a[72:75], v[24:27]
    v_mfma_f32_16x16x32_bf16 v[28:31], v[116:119], a[76:79], v[28:31]
    s_waitcnt vmcnt(11)
    buffer_load_dwordx4 v[108:111], v6, s[36:39], s77 offen offset:3072 sc1
    v_mfma_f32_16x16x32_bf16 v[32:35], v[120:123], a[64:67], v[32:35]
    v_mfma_f32_16x16x32_bf16 v[36:39], v[120:123], a[68:71], v[36:39]
    v_mfma_f32_16x16x32_bf16 v[40:43], v[120:123], a[72:75], v[40:43]
    v_mfma_f32_16x16x32_bf16 v[44:47], v[120:123], a[76:79], v[44:47]
    s_waitcnt vmcnt(11)
    buffer_load_dwordx4 v[112:115], v7, s[36:39], s77 offen offset:0 sc1
    v_mfma_f32_16x16x32_bf16 v[48:51], v[124:127], a[64:67], v[48:51]
    v_mfma_f32_16x16x32_bf16 v[52:55], v[124:127], a[68:71], v[52:55]
    v_mfma_f32_16x16x32_bf16 v[56:59], v[124:127], a[72:75], v[56:59]
    v_mfma_f32_16x16x32_bf16 v[60:63], v[124:127], a[76:79], v[60:63]
    s_waitcnt vmcnt(11)
    s_add_u32 s72, s75, 7
    s_cmp_ge_u32 s72, 14
    s_cselect_b32 s77, 14, 0
    s_sub_u32 s72, s72, s77
    s_mul_i32 s72, s72, 40960
    s_add_u32 s77, s72, s76
    buffer_load_dwordx4 v[116:119], v6, s[36:39], s77 offen offset:0 sc1
    v_mfma_f32_16x16x32_bf16 v[64:67], v[128:131], a[64:67], v[64:67]
    v_mfma_f32_16x16x32_bf16 v[68:71], v[128:131], a[68:71], v[68:71]
    v_mfma_f32_16x16x32_bf16 v[72:75], v[128:131], a[72:75], v[72:75]
    v_mfma_f32_16x16x32_bf16 v[76:79], v[128:131], a[76:79], v[76:79]
    s_waitcnt vmcnt(11)
    buffer_load_dwordx4 v[120:123], v6, s[36:39], s77 offen offset:1024 sc1
    v_mfma_f32_16x16x32_bf16 v[80:83], v[132:135], a[64:67], v[80:83]
    v_mfma_f32_16x16x32_bf16 v[84:87], v[132:135], a[68:71], v[84:87]
    v_mfma_f32_16x16x32_bf16 v[88:91], v[132:135], a[72:75], v[88:91]
    v_mfma_f32_16x16x32_bf16 v[92:95], v[132:135], a[76:79], v[92:95]
    s_waitcnt vmcnt(11)
    buffer_load_dwordx4 v[124:127], v6, s[36:39], s77 offen offset:2048 sc1
    v_mfma_f32_16x16x32_bf16 v[16:19], v[136:139], a[80:83], v[16:19]
    v_mfma_f32_16x16x32_bf16 v[20:23], v[136:139], a[84:87], v[20:23]
    v_mfma_f32_16x16x32_bf16 v[24:27], v[136:139], a[88:91], v[24:27]
    v_mfma_f32_16x16x32_bf16 v[28:31], v[136:139], a[92:95], v[28:31]
    s_waitcnt vmcnt(11)
    buffer_load_dwordx4 v[128:131], v6, s[36:39], s77 offen offset:3072 sc1
    v_mfma_f32_16x16x32_bf16 v[32:35], v[140:143], a[80:83], v[32:35]
    v_mfma_f32_16x16x32_bf16 v[36:39], v[140:143], a[84:87], v[36:39]
    v_mfma_f32_16x16x32_bf16 v[40:43], v[140:143], a[88:91], v[40:43]
    v_mfma_f32_16x16x32_bf16 v[44:47], v[140:143], a[92:95], v[44:47]
    s_waitcnt vmcnt(11)
    buffer_load_dwordx4 v[132:135], v7, s[36:39], s77 offen offset:0 sc1
    v_mfma_f32_16x16x32_bf16 v[48:51], v[144:147], a[80:83], v[48:51]
    v_mfma_f32_16x16x32_bf16 v[52:55], v[144:147], a[84:87], v[52:55]
    v_mfma_f32_16x16x32_bf16 v[56:59], v[144:147], a[88:91], v[56:59]
    v_mfma_f32_16x16x32_bf16 v[60:63], v[144:147], a[92:95], v[60:63]
    s_waitcnt vmcnt(11)
    s_add_u32 s72, s75, 8
    s_cmp_ge_u32 s72, 14
    s_cselect_b32 s77, 14, 0
    s_sub_u32 s72, s72, s77
    s_mul_i32 s72, s72, 40960
    s_add_u32 s77, s72, s76
    buffer_load_dwordx4 v[136:139], v6, s[36:39], s77 offen offset:0 sc1
    v_mfma_f32_16x16x32_bf16 v[64:67], v[148:151], a[80:83], v[64:67]
    v_mfma_f32_16x16x32_bf16 v[68:71], v[148:151], a[84:87], v[68:71]
    v_mfma_f32_16x16x32_bf16 v[72:75], v[148:151], a[88:91], v[72:75]
    v_mfma_f32_16x16x32_bf16 v[76:79], v[148:151], a[92:95], v[76:79]
    s_waitcnt vmcnt(11)
    buffer_load_dwordx4 v[140:143], v6, s[36:39], s77 offen offset:1024 sc1
    v_mfma_f32_16x16x32_bf16 v[80:83], v[152:155], a[80:83], v[80:83]
    v_mfma_f32_16x16x32_bf16 v[84:87], v[152:155], a[84:87], v[84:87]
    v_mfma_f32_16x16x32_bf16 v[88:91], v[152:155], a[88:91], v[88:91]
    v_mfma_f32_16x16x32_bf16 v[92:95], v[152:155], a[92:95], v[92:95]
    s_waitcnt vmcnt(11)
    buffer_load_dwordx4 v[144:147], v6, s[36:39], s77 offen offset:2048 sc1
    v_mfma_f32_16x16x32_bf16 v[16:19], v[96:99], a[96:99], v[16:19]
    v_mfma_f32_16x16x32_bf16 v[20:23], v[96:99], a[100:103], v[20:23]
    v_mfma_f32_16x16x32_bf16 v[24:27], v[96:99], a[104:107], v[24:27]
    v_mfma_f32_16x16x32_bf16 v[28:31], v[96:99], a[108:111], v[28:31]
    s_waitcnt vmcnt(11)
    buffer_load_dwordx4 v[148:151], v6, s[36:39], s77 offen offset:3072 sc1
    v_mfma_f32_16x16x32_bf16 v[32:35], v[100:103], a[96:99], v[32:35]
    v_mfma_f32_16x16x32_bf16 v[36:39], v[100:103], a[100:103], v[36:39]
    v_mfma_f32_16x16x32_bf16 v[40:43], v[100:103], a[104:107], v[40:43]
    v_mfma_f32_16x16x32_bf16 v[44:47], v[100:103], a[108:111], v[44:47]
    s_waitcnt vmcnt(11)
    buffer_load_dwordx4 v[152:155], v7, s[36:39], s77 offen offset:0 sc1
    v_mfma_f32_16x16x32_bf16 v[48:51], v[104:107], a[96:99], v[48:51]
    v_mfma_f32_16x16x32_bf16 v[52:55], v[104:107], a[100:103], v[52:55]
    v_mfma_f32_16x16x32_bf16 v[56:59], v[104:107], a[104:107], v[56:59]
    v_mfma_f32_16x16x32_bf16 v[60:63], v[104:107], a[108:111], v[60:63]
    s_waitcnt vmcnt(11)
    s_add_u32 s72, s75, 9
    s_cmp_ge_u32 s72, 14
    s_cselect_b32 s77, 14, 0
    s_sub_u32 s72, s72, s77
    s_mul_i32 s72, s72, 40960
    s_add_u32 s77, s72, s76
    buffer_load_dwordx4 v[96:99], v6, s[36:39], s77 offen offset:0 sc1
    v_mfma_f32_16x16x32_bf16 v[64:67], v[108:111], a[96:99], v[64:67]
    v_mfma_f32_16x16x32_bf16 v[68:71], v[108:111], a[100:103], v[68:71]
    v_mfma_f32_16x16x32_bf16 v[72:75], v[108:111], a[104:107], v[72:75]
    v_mfma_f32_16x16x32_bf16 v[76:79], v[108:111], a[108:111], v[76:79]
    s_waitcnt vmcnt(11)
    buffer_load_dwordx4 v[100:103], v6, s[36:39], s77 offen offset:1024 sc1
    v_mfma_f32_16x16x32_bf16 v[80:83], v[112:115], a[96:99], v[80:83]
    v_mfma_f32_16x16x32_bf16 v[84:87], v[112:115], a[100:103], v[84:87]
    v_mfma_f32_16x16x32_bf16 v[88:91], v[112:115], a[104:107], v[88:91]
    v_mfma_f32_16x16x32_bf16 v[92:95], v[112:115], a[108:111], v[92:95]
    s_waitcnt vmcnt(11)
    buffer_load_dwordx4 v[104:107], v6, s[36:39], s77 offen offset:2048 sc1
    v_mfma_f32_16x16x32_bf16 v[16:19], v[116:119], a[112:115], v[16:19]
    v_mfma_f32_16x16x32_bf16 v[20:23], v[116:119], a[116:119], v[20:23]
    v_mfma_f32_16x16x32_bf16 v[24:27], v[116:119], a[120:123], v[24:27]
    v_mfma_f32_16x16x32_bf16 v[28:31], v[116:119], a[124:127], v[28:31]
    s_waitcnt vmcnt(11)
    buffer_load_dwordx4 v[108:111], v6, s[36:39], s77 offen offset:3072 sc1
    v_mfma_f32_16x16x32_bf16 v[32:35], v[120:123], a[112:115], v[32:35]
    v_mfma_f32_16x16x32_bf16 v[36:39], v[120:123], a[116:119], v[36:39]
    v_mfma_f32_16x16x32_bf16 v[40:43], v[120:123], a[120:123], v[40:43]
    v_mfma_f32_16x16x32_bf16 v[44:47], v[120:123], a[124:127], v[44:47]
    s_waitcnt vmcnt(11)
    buffer_load_dwordx4 v[112:115], v7, s[36:39], s77 offen offset:0 sc1
    v_mfma_f32_16x16x32_bf16 v[48:51], v[124:127], a[112:115], v[48:51]
    v_mfma_f32_16x16x32_bf16 v[52:55], v[124:127], a[116:119], v[52:55]
    v_mfma_f32_16x16x32_bf16 v[56:59], v[124:127], a[120:123], v[56:59]
    v_mfma_f32_16x16x32_bf16 v[60:63], v[124:127], a[124:127], v[60:63]
    s_waitcnt vmcnt(11)
    s_add_u32 s72, s75, 10
    s_cmp_ge_u32 s72, 14
    s_cselect_b32 s77, 14, 0
    s_sub_u32 s72, s72, s77
    s_mul_i32 s72, s72, 40960
    s_add_u32 s77, s72, s76
    buffer_load_dwordx4 v[116:119], v6, s[36:39], s77 offen offset:0 sc1
    v_mfma_f32_16x16x32_bf16 v[64:67], v[128:131], a[112:115], v[64:67]
    v_mfma_f32_16x16x32_bf16 v[68:71], v[128:131], a[116:119], v[68:71]
    v_mfma_f32_16x16x32_bf16 v[72:75], v[128:131], a[120:123], v[72:75]
    v_mfma_f32_16x16x32_bf16 v[76:79], v[128:131], a[124:127], v[76:79]
    s_waitcnt vmcnt(11)
    buffer_load_dwordx4 v[120:123], v6, s[36:39], s77 offen offset:1024 sc1
    v_mfma_f32_16x16x32_bf16 v[80:83], v[132:135], a[112:115], v[80:83]
    v_mfma_f32_16x16x32_bf16 v[84:87], v[132:135], a[116:119], v[84:87]
    v_mfma_f32_16x16x32_bf16 v[88:91], v[132:135], a[120:123], v[88:91]
    v_mfma_f32_16x16x32_bf16 v[92:95], v[132:135], a[124:127], v[92:95]
    s_waitcnt vmcnt(11)
    buffer_load_dwordx4 v[124:127], v6, s[36:39], s77 offen offset:2048 sc1
    v_mfma_f32_16x16x32_bf16 v[16:19], v[136:139], a[128:131], v[16:19]
    v_mfma_f32_16x16x32_bf16 v[20:23], v[136:139], a[132:135], v[20:23]
    v_mfma_f32_16x16x32_bf16 v[24:27], v[136:139], a[136:139], v[24:27]
    v_mfma_f32_16x16x32_bf16 v[28:31], v[136:139], a[140:143], v[28:31]
    s_waitcnt vmcnt(11)
    buffer_load_dwordx4 v[128:131], v6, s[36:39], s77 offen offset:3072 sc1
    v_mfma_f32_16x16x32_bf16 v[32:35], v[140:143], a[128:131], v[32:35]
    v_mfma_f32_16x16x32_bf16 v[36:39], v[140:143], a[132:135], v[36:39]
    v_mfma_f32_16x16x32_bf16 v[40:43], v[140:143], a[136:139], v[40:43]
    v_mfma_f32_16x16x32_bf16 v[44:47], v[140:143], a[140:143], v[44:47]
    s_waitcnt vmcnt(11)
    buffer_load_dwordx4 v[132:135], v7, s[36:39], s77 offen offset:0 sc1
    v_mfma_f32_16x16x32_bf16 v[48:51], v[144:147], a[128:131], v[48:51]
    v_mfma_f32_16x16x32_bf16 v[52:55], v[144:147], a[132:135], v[52:55]
    v_mfma_f32_16x16x32_bf16 v[56:59], v[144:147], a[136:139], v[56:59]
    v_mfma_f32_16x16x32_bf16 v[60:63], v[144:147], a[140:143], v[60:63]
    s_waitcnt vmcnt(11)
    s_add_u32 s72, s75, 11
    s_cmp_ge_u32 s72, 14
    s_cselect_b32 s77, 14, 0
    s_sub_u32 s72, s72, s77
    s_mul_i32 s72, s72, 40960
    s_add_u32 s77, s72, s76
    buffer_load_dwordx4 v[136:139], v6, s[36:39], s77 offen offset:0 sc1
    v_mfma_f32_16x16x32_bf16 v[64:67], v[148:151], a[128:131], v[64:67]
    v_mfma_f32_16x16x32_bf16 v[68:71], v[148:151], a[132:135], v[68:71]
    v_mfma_f32_16x16x32_bf16 v[72:75], v[148:151], a[136:139], v[72:75]
    v_mfma_f32_16x16x32_bf16 v[76:79], v[148:151], a[140:143], v[76:79]
    s_waitcnt vmcnt(11)
    buffer_load_dwordx4 v[140:143], v6, s[36:39], s77 offen offset:1024 sc1
    v_mfma_f32_16x16x32_bf16 v[80:83], v[152:155], a[128:131], v[80:83]
    v_mfma_f32_16x16x32_bf16 v[84:87], v[152:155], a[132:135], v[84:87]
    v_mfma_f32_16x16x32_bf16 v[88:91], v[152:155], a[136:139], v[88:91]
    v_mfma_f32_16x16x32_bf16 v[92:95], v[152:155], a[140:143], v[92:95]
    s_waitcnt vmcnt(11)
    buffer_load_dwordx4 v[144:147], v6, s[36:39], s77 offen offset:2048 sc1
    v_mfma_f32_16x16x32_bf16 v[16:19], v[96:99], a[144:147], v[16:19]
    v_mfma_f32_16x16x32_bf16 v[20:23], v[96:99], a[148:151], v[20:23]
    v_mfma_f32_16x16x32_bf16 v[24:27], v[96:99], a[152:155], v[24:27]
    v_mfma_f32_16x16x32_bf16 v[28:31], v[96:99], a[156:159], v[28:31]
    s_waitcnt vmcnt(11)
    buffer_load_dwordx4 v[148:151], v6, s[36:39], s77 offen offset:3072 sc1
    v_mfma_f32_16x16x32_bf16 v[32:35], v[100:103], a[144:147], v[32:35]
    v_mfma_f32_16x16x32_bf16 v[36:39], v[100:103], a[148:151], v[36:39]
    v_mfma_f32_16x16x32_bf16 v[40:43], v[100:103], a[152:155], v[40:43]
    v_mfma_f32_16x16x32_bf16 v[44:47], v[100:103], a[156:159], v[44:47]
    s_waitcnt vmcnt(11)
    buffer_load_dwordx4 v[152:155], v7, s[36:39], s77 offen offset:0 sc1
    v_mfma_f32_16x16x32_bf16 v[48:51], v[104:107], a[144:147], v[48:51]
    v_mfma_f32_16x16x32_bf16 v[52:55], v[104:107], a[148:151], v[52:55]
    v_mfma_f32_16x16x32_bf16 v[56:59], v[104:107], a[152:155], v[56:59]
    v_mfma_f32_16x16x32_bf16 v[60:63], v[104:107], a[156:159], v[60:63]
    s_waitcnt vmcnt(11)
    s_add_u32 s72, s75, 12
    s_cmp_ge_u32 s72, 14
    s_cselect_b32 s77, 14, 0
    s_sub_u32 s72, s72, s77
    s_mul_i32 s72, s72, 40960
    s_add_u32 s77, s72, s76
    buffer_load_dwordx4 v[96:99], v6, s[36:39], s77 offen offset:0 sc1
    v_mfma_f32_16x16x32_bf16 v[64:67], v[108:111], a[144:147], v[64:67]
    v_mfma_f32_16x16x32_bf16 v[68:71], v[108:111], a[148:151], v[68:71]
    v_mfma_f32_16x16x32_bf16 v[72:75], v[108:111], a[152:155], v[72:75]
    v_mfma_f32_16x16x32_bf16 v[76:79], v[108:111], a[156:159], v[76:79]
    s_waitcnt vmcnt(11)
    buffer_load_dwordx4 v[100:103], v6, s[36:39], s77 offen offset:1024 sc1
    v_mfma_f32_16x16x32_bf16 v[80:83], v[112:115], a[144:147], v[80:83]
    v_mfma_f32_16x16x32_bf16 v[84:87], v[112:115], a[148:151], v[84:87]
    v_mfma_f32_16x16x32_bf16 v[88:91], v[112:115], a[152:155], v[88:91]
    v_mfma_f32_16x16x32_bf16 v[92:95], v[112:115], a[156:159], v[92:95]
    s_waitcnt vmcnt(11)
    buffer_load_dwordx4 v[104:107], v6, s[36:39], s77 offen offset:2048 sc1
    v_mfma_f32_16x16x32_bf16 v[16:19], v[116:119], a[160:163], v[16:19]
    v_mfma_f32_16x16x32_bf16 v[20:23], v[116:119], a[164:167], v[20:23]
    v_mfma_f32_16x16x32_bf16 v[24:27], v[116:119], a[168:171], v[24:27]
    v_mfma_f32_16x16x32_bf16 v[28:31], v[116:119], a[172:175], v[28:31]
    s_waitcnt vmcnt(11)
    buffer_load_dwordx4 v[108:111], v6, s[36:39], s77 offen offset:3072 sc1
    v_mfma_f32_16x16x32_bf16 v[32:35], v[120:123], a[160:163], v[32:35]
    v_mfma_f32_16x16x32_bf16 v[36:39], v[120:123], a[164:167], v[36:39]
    v_mfma_f32_16x16x32_bf16 v[40:43], v[120:123], a[168:171], v[40:43]
    v_mfma_f32_16x16x32_bf16 v[44:47], v[120:123], a[172:175], v[44:47]
    s_waitcnt vmcnt(11)
    buffer_load_dwordx4 v[112:115], v7, s[36:39], s77 offen offset:0 sc1
    v_mfma_f32_16x16x32_bf16 v[48:51], v[124:127], a[160:163], v[48:51]
    v_mfma_f32_16x16x32_bf16 v[52:55], v[124:127], a[164:167], v[52:55]
    v_mfma_f32_16x16x32_bf16 v[56:59], v[124:127], a[168:171], v[56:59]
    v_mfma_f32_16x16x32_bf16 v[60:63], v[124:127], a[172:175], v[60:63]
    s_waitcnt vmcnt(11)
    s_add_u32 s72, s75, 13
    s_cmp_ge_u32 s72, 14
    s_cselect_b32 s77, 14, 0
    s_sub_u32 s72, s72, s77
    s_mul_i32 s72, s72, 40960
    s_add_u32 s77, s72, s76
    buffer_load_dwordx4 v[116:119], v6, s[36:39], s77 offen offset:0 sc1
    v_mfma_f32_16x16x32_bf16 v[64:67], v[128:131], a[160:163], v[64:67]
    v_mfma_f32_16x16x32_bf16 v[68:71], v[128:131], a[164:167], v[68:71]
    v_mfma_f32_16x16x32_bf16 v[72:75], v[128:131], a[168:171], v[72:75]
    v_mfma_f32_16x16x32_bf16 v[76:79], v[128:131], a[172:175], v[76:79]
    s_waitcnt vmcnt(11)
    buffer_load_dwordx4 v[120:123], v6, s[36:39], s77 offen offset:1024 sc1
    v_mfma_f32_16x16x32_bf16 v[80:83], v[132:135], a[160:163], v[80:83]
    v_mfma_f32_16x16x32_bf16 v[84:87], v[132:135], a[164:167], v[84:87]
    v_mfma_f32_16x16x32_bf16 v[88:91], v[132:135], a[168:171], v[88:91]
    v_mfma_f32_16x16x32_bf16 v[92:95], v[132:135], a[172:175], v[92:95]
    s_waitcnt vmcnt(11)
    buffer_load_dwordx4 v[124:127], v6, s[36:39], s77 offen offset:2048 sc1
    v_mfma_f32_16x16x32_bf16 v[16:19], v[136:139], a[176:179], v[16:19]
    v_mfma_f32_16x16x32_bf16 v[20:23], v[136:139], a[180:183], v[20:23]
    v_mfma_f32_16x16x32_bf16 v[24:27], v[136:139], a[184:187], v[24:27]
    v_mfma_f32_16x16x32_bf16 v[28:31], v[136:139], a[188:191], v[28:31]
    s_waitcnt vmcnt(11)
    buffer_load_dwordx4 v[128:131], v6, s[36:39], s77 offen offset:3072 sc1
    v_mfma_f32_16x16x32_bf16 v[32:35], v[140:143], a[176:179], v[32:35]
    v_mfma_f32_16x16x32_bf16 v[36:39], v[140:143], a[180:183], v[36:39]
    v_mfma_f32_16x16x32_bf16 v[40:43], v[140:143], a[184:187], v[40:43]
    v_mfma_f32_16x16x32_bf16 v[44:47], v[140:143], a[188:191], v[44:47]
    s_waitcnt vmcnt(11)
    buffer_load_dwordx4 v[132:135], v7, s[36:39], s77 offen offset:0 sc1
    v_mfma_f32_16x16x32_bf16 v[48:51], v[144:147], a[176:179], v[48:51]
    v_mfma_f32_16x16x32_bf16 v[52:55], v[144:147], a[180:183], v[52:55]
    v_mfma_f32_16x16x32_bf16 v[56:59], v[144:147], a[184:187], v[56:59]
    v_mfma_f32_16x16x32_bf16 v[60:63], v[144:147], a[188:191], v[60:63]
    s_waitcnt vmcnt(11)
    v_mfma_f32_16x16x32_bf16 v[64:67], v[148:151], a[176:179], v[64:67]
    v_mfma_f32_16x16x32_bf16 v[68:71], v[148:151], a[180:183], v[68:71]
    v_mfma_f32_16x16x32_bf16 v[72:75], v[148:151], a[184:187], v[72:75]
    v_mfma_f32_16x16x32_bf16 v[76:79], v[148:151], a[188:191], v[76:79]
    s_waitcnt vmcnt(10)
    v_mfma_f32_16x16x32_bf16 v[80:83], v[152:155], a[176:179], v[80:83]
    v_mfma_f32_16x16x32_bf16 v[84:87], v[152:155], a[180:183], v[84:87]
    v_mfma_f32_16x16x32_bf16 v[88:91], v[152:155], a[184:187], v[88:91]
    v_mfma_f32_16x16x32_bf16 v[92:95], v[152:155], a[188:191], v[92:95]
    v_and_b32 v15, 15, v1
    s_lshl_b32 s68, s60, 4
    v_add_u32 v15, s68, v15
    v_mul_u32_u24 v6, 1280, v15
    v_lshrrev_b32 v15, 4, v1
    v_lshlrev_b32 v15, 3, v15
    v_add_u32 v6, v6, v15
    s_mul_i32 s68, s65, 81920
    s_mul_i32 s69, s66, 160
    s_add_u32 s77, s68, s69
    v_lshlrev_b32 v204, 16, v14
    v_lshlrev_b32 v205, 16, v14
    v_sub_u32 v7, v6, v15
    v_bfe_u32 v15, v1, 4, 1
    v_lshlrev_b32 v15, 5, v15
    v_add_u32 v7, v7, v15
    v_bfe_u32 v15, v1, 5, 1
    v_lshlrev_b32 v15, 4, v15
    v_add_u32 v7, v7, v15
    s_cmp_lg_u32 s60, 0
    s_cbranch_scc1 L_ep2_1
    s_waitcnt vmcnt(9)
    s_waitcnt vmcnt(4)
    v_mfma_f32_16x16x32_bf16 v[20:23], v[96:99], a[196:199], v[20:23]
    v_mfma_f32_16x16x32_bf16 v[24:27], v[96:99], a[200:203], v[24:27]
    v_mfma_f32_16x16x32_bf16 v[20:23], v[116:119], a[212:215], v[20:23]
    v_mfma_f32_16x16x32_bf16 v[24:27], v[116:119], a[216:219], v[24:27]
    s_waitcnt vmcnt(3)
    v_mfma_f32_16x16x32_bf16 v[28:31], v[96:99], a[204:207], v[28:31]
    v_mfma_f32_16x16x32_bf16 v[36:39], v[100:103], a[196:199], v[36:39]
    v_mfma_f32_16x16x32_bf16 v[28:31], v[116:119], a[220:223], v[28:31]
    v_mfma_f32_16x16x32_bf16 v[36:39], v[120:123], a[212:215], v[36:39]
    v_mfma_f32_16x16x32_bf16 v[40:43], v[100:103], a[200:203], v[40:43]
    v_mfma_f32_16x16x32_bf16 v[44:47], v[100:103], a[204:207], v[44:47]
    v_mfma_f32_16x16x32_bf16 v[40:43], v[120:123], a[216:219], v[40:43]
    v_mfma_f32_16x16x32_bf16 v[44:47], v[120:123], a[220:223], v[44:47]
    ds_write_b128 v200, v[20:23] offset:0
    s_waitcnt vmcnt(2)
    v_mfma_f32_16x16x32_bf16 v[52:55], v[104:107], a[196:199], v[52:55]
    ds_write_b128 v200, v[24:27] offset:5120
    v_mfma_f32_16x16x32_bf16 v[56:59], v[104:107], a[200:203], v[56:59]
    ds_write_b128 v200, v[28:31] offset:10240
    v_mfma_f32_16x16x32_bf16 v[52:55], v[124:127], a[212:215], v[52:55]
    ds_write_b128 v200, v[36:39] offset:1024
    v_mfma_f32_16x16x32_bf16 v[56:59], v[124:127], a[216:219], v[56:59]
    ds_write_b128 v200, v[40:43] offset:6144
    s_waitcnt vmcnt(1)
    v_mfma_f32_16x16x32_bf16 v[60:63], v[104:107], a[204:207], v[60:63]
    ds_write_b128 v200, v[44:47] offset:11264
    v_mfma_f32_16x16x32_bf16 v[68:71], v[108:111], a[196:199], v[68:71]
    v_mfma_f32_16x16x32_bf16 v[60:63], v[124:127], a[220:223], v[60:63]
    v_mfma_f32_16x16x32_bf16 v[68:71], v[128:131], a[212:215], v[68:71]
    v_mfma_f32_16x16x32_bf16 v[72:75], v[108:111], a[200:203], v[72:75]
    ds_write_b128 v200, v[52:55] offset:2048
    v_mfma_f32_16x16x32_bf16 v[76:79], v[108:111], a[204:207], v[76:79]
    ds_write_b128 v200, v[56:59] offset:7168
    v_mfma_f32_16x16x32_bf16 v[72:75], v[128:131], a[216:219], v[72:75]
    v_mfma_f32_16x16x32_bf16 v[76:79], v[128:131], a[220:223], v[76:79]
    s_waitcnt vmcnt(0)
    v_mfma_f32_16x16x32_bf16 v[84:87], v[112:115], a[196:199], v[84:87]
    v_mfma_f32_16x16x32_bf16 v[88:91], v[112:115], a[200:203], v[88:91]
    ds_write_b128 v200, v[60:63] offset:12288
    v_mfma_f32_16x16x32_bf16 v[84:87], v[132:135], a[212:215], v[84:87]
    ds_write_b128 v200, v[68:71] offset:3072
    v_mfma_f32_16x16x32_bf16 v[88:91], v[132:135], a[216:219], v[88:91]
    v_mfma_f32_16x16x32_bf16 v[92:95], v[112:115], a[204:207], v[92:95]
    v_mfma_f32_16x16x32_bf16 v[16:19], v[96:99], a[192:195], v[16:19]
    ds_write_b128 v200, v[72:75] offset:8192
    v_mfma_f32_16x16x32_bf16 v[92:95], v[132:135], a[220:223], v[92:95]
    ds_write_b128 v200, v[76:79] offset:13312
    v_mfma_f32_16x16x32_bf16 v[16:19], v[116:119], a[208:211], v[16:19]
    v_mfma_f32_16x16x32_bf16 v[32:35], v[100:103], a[192:195], v[32:35]
    ds_write_b128 v200, v[84:87] offset:4096
    v_mfma_f32_16x16x32_bf16 v[48:51], v[104:107], a[192:195], v[48:51]
    ds_write_b128 v200, v[88:91] offset:9216
    v_mfma_f32_16x16x32_bf16 v[32:35], v[120:123], a[208:211], v[32:35]
    v_mfma_f32_16x16x32_bf16 v[48:51], v[124:127], a[208:211], v[48:51]
    v_mfma_f32_16x16x32_bf16 v[64:67], v[108:111], a[192:195], v[64:67]
    ds_write_b128 v200, v[92:95] offset:14336
    v_mfma_f32_16x16x32_bf16 v[80:83], v[112:115], a[192:195], v[80:83]
    v_mfma_f32_16x16x32_bf16 v[64:67], v[128:131], a[208:211], v[64:67]
    v_mfma_f32_16x16x32_bf16 v[80:83], v[132:135], a[208:211], v[80:83]
    s_waitcnt lgkmcnt(0)
    s_barrier
    s_and_b32 s68, s66, 1
    s_cmp_lg_u32 s68, 0
    s_cbranch_scc1 L_odd_0
    ds_read_b128 v[96:99], v200 offset:32768
    ds_read_b128 v[100:103], v201 offset:0
    ds_read_b128 v[104:107], v201 offset:32768
    ds_read_b128 v[108:111], v200 offset:33792
    ds_read_b128 v[112:115], v201 offset:1024
    ds_read_b128 v[116:119], v201 offset:33792
    ds_read_b128 v[120:123], v200 offset:34816
    ds_read_b128 v[124:127], v201 offset:2048
    ds_read_b128 v[128:131], v201 offset:34816
    ds_read_b128 v[132:135], v200 offset:35840
    ds_read_b128 v[136:139], v201 offset:3072
    ds_read_b128 v[140:143], v201 offset:35840
    ds_read_b128 v[144:147], v200 offset:36864
    ds_read_b128 v[148:151], v201 offset:4096
    ds_read_b128 v[152:155], v201 offset:36864
    s_waitcnt lgkmcnt(14)
    v_pk_add_f32 v[16:17], v[16:17], v[96:97]
    v_pk_add_f32 v[18:19], v[18:19], v[98:99]
    s_waitcnt lgkmcnt(13)
    v_pk_add_f32 v[16:17], v[16:17], v[100:101]
    v_pk_add_f32 v[18:19], v[18:19], v[102:103]
    s_waitcnt lgkmcnt(12)
    v_pk_add_f32 v[16:17], v[16:17], v[104:105]
    v_pk_add_f32 v[18:19], v[18:19], v[106:107]
    v_pk_add_f32 v[16:17], v[16:17], v[204:205]
    v_pk_add_f32 v[18:19], v[18:19], v[204:205]
    v_cvt_pk_bf16_f32 v160, v16, v17
    v_cvt_pk_bf16_f32 v161, v18, v19
    s_waitcnt lgkmcnt(11)
    v_pk_add_f32 v[32:33], v[32:33], v[108:109]
    v_pk_add_f32 v[34:35], v[34:35], v[110:111]
    s_waitcnt lgkmcnt(10)
    v_pk_add_f32 v[32:33], v[32:33], v[112:113]
    v_pk_add_f32 v[34:35], v[34:35], v[114:115]
    s_waitcnt lgkmcnt(9)
    v_pk_add_f32 v[32:33], v[32:33], v[116:117]
    v_pk_add_f32 v[34:35], v[34:35], v[118:119]
    v_pk_add_f32 v[32:33], v[32:33], v[204:205]
    v_pk_add_f32 v[34:35], v[34:35], v[204:205]
    v_cvt_pk_bf16_f32 v162, v32, v33
    v_cvt_pk_bf16_f32 v163, v34, v35
    s_nop 1
    v_permlane16_swap_b32 v160, v162
    v_permlane16_swap_b32 v161, v163
    buffer_store_dwordx4 v[160:163], v7, s[40:43], s77 offen offset:0 sc0 sc1
    s_waitcnt lgkmcnt(8)
    v_pk_add_f32 v[48:49], v[48:49], v[120:121]
    v_pk_add_f32 v[50:51], v[50:51], v[122:123]
    s_waitcnt lgkmcnt(7)
    v_pk_add_f32 v[48:49], v[48:49], v[124:125]
    v_pk_add_f32 v[50:51], v[50:51], v[126:127]
    s_waitcnt lgkmcnt(6)
    v_pk_add_f32 v[48:49], v[48:49], v[128:129]
    v_pk_add_f32 v[50:51], v[50:51], v[130:131]
    v_pk_add_f32 v[48:49], v[48:49], v[204:205]
    v_pk_add_f32 v[50:51], v[50:51], v[204:205]
    v_cvt_pk_bf16_f32 v164, v48, v49
    v_cvt_pk_bf16_f32 v165, v50, v51
    s_waitcnt lgkmcnt(5)
    v_pk_add_f32 v[64:65], v[64:65], v[132:133]
    v_pk_add_f32 v[66:67], v[66:67], v[134:135]
    s_waitcnt lgkmcnt(4)
    v_pk_add_f32 v[64:65], v[64:65], v[136:137]
    v_pk_add_f32 v[66:67], v[66:67], v[138:139]
    s_waitcnt lgkmcnt(3)
    v_pk_add_f32 v[64:65], v[64:65], v[140:141]
    v_pk_add_f32 v[66:67], v[66:67], v[142:143]
    v_pk_add_f32 v[64:65], v[64:65], v[204:205]
    v_pk_add_f32 v[66:67], v[66:67], v[204:205]
    v_cvt_pk_bf16_f32 v166, v64, v65
    v_cvt_pk_bf16_f32 v167, v66, v67
    s_nop 1
    v_permlane16_swap_b32 v164, v166
    v_permlane16_swap_b32 v165, v167
    buffer_store_dwordx4 v[164:167], v7, s[40:43], s77 offen offset:64 sc0 sc1
    s_waitcnt lgkmcnt(2)
    v_pk_add_f32 v[80:81], v[80:81], v[144:145]
    v_pk_add_f32 v[82:83], v[82:83], v[146:147]
    s_waitcnt lgkmcnt(1)
    v_pk_add_f32 v[80:81], v[80:81], v[148:149]
    v_pk_add_f32 v[82:83], v[82:83], v[150:151]
    s_waitcnt lgkmcnt(0)
    v_pk_add_f32 v[80:81], v[80:81], v[152:153]
    v_pk_add_f32 v[82:83], v[82:83], v[154:155]
    v_pk_add_f32 v[80:81], v[80:81], v[204:205]
    v_pk_add_f32 v[82:83], v[82:83], v[204:205]
    v_cvt_pk_bf16_f32 v168, v80, v81
    v_cvt_pk_bf16_f32 v169, v82, v83
    buffer_store_dwordx2 v[168:169], v6, s[40:43], s77 offen offset:128 sc0 sc1
    s_branch L_fin
L_odd_0:
    ds_read_b128 v[96:99], v200 offset:32768
    ds_read_b128 v[100:103], v201 offset:0
    ds_read_b128 v[104:107], v201 offset:32768
    ds_read_b128 v[108:111], v200 offset:33792
    ds_read_b128 v[112:115], v201 offset:1024
    ds_read_b128 v[116:119], v201 offset:33792
    ds_read_b128 v[120:123], v200 offset:34816
    ds_read_b128 v[124:127], v201 offset:2048
    ds_read_b128 v[128:131], v201 offset:34816
    ds_read_b128 v[132:135], v200 offset:35840
    ds_read_b128 v[136:139], v201 offset:3072
    ds_read_b128 v[140:143], v201 offset:35840
    ds_read_b128 v[144:147], v200 offset:36864
    ds_read_b128 v[148:151], v201 offset:4096
    ds_read_b128 v[152:155], v201 offset:36864
    s_waitcnt lgkmcnt(14)
    v_pk_add_f32 v[16:17], v[16:17], v[96:97]
    v_pk_add_f32 v[18:19], v[18:19], v[98:99]
    s_waitcnt lgkmcnt(13)
    v_pk_add_f32 v[16:17], v[16:17], v[100:101]
    v_pk_add_f32 v[18:19], v[18:19], v[102:103]
    s_waitcnt lgkmcnt(12)
    v_pk_add_f32 v[16:17], v[16:17], v[104:105]
    v_pk_add_f32 v[18:19], v[18:19], v[106:107]
    v_pk_add_f32 v[16:17], v[16:17], v[204:205]
    v_pk_add_f32 v[18:19], v[18:19], v[204:205]
    v_cvt_pk_bf16_f32 v168, v16, v17
    v_cvt_pk_bf16_f32 v169, v18, v19
    buffer_store_dwordx2 v[168:169], v6, s[40:43], s77 offen offset:0 sc0 sc1
    s_waitcnt lgkmcnt(11)
    v_pk_add_f32 v[32:33], v[32:33], v[108:109]
    v_pk_add_f32 v[34:35], v[34:35], v[110:111]
    s_waitcnt lgkmcnt(10)
    v_pk_add_f32 v[32:33], v[32:33], v[112:113]
    v_pk_add_f32 v[34:35], v[34:35], v[114:115]
    s_waitcnt lgkmcnt(9)
    v_pk_add_f32 v[32:33], v[32:33], v[116:117]
    v_pk_add_f32 v[34:35], v[34:35], v[118:119]
    v_pk_add_f32 v[32:33], v[32:33], v[204:205]
    v_pk_add_f32 v[34:35], v[34:35], v[204:205]
    v_cvt_pk_bf16_f32 v160, v32, v33
    v_cvt_pk_bf16_f32 v161, v34, v35
    s_waitcnt lgkmcnt(8)
    v_pk_add_f32 v[48:49], v[48:49], v[120:121]
    v_pk_add_f32 v[50:51], v[50:51], v[122:123]
    s_waitcnt lgkmcnt(7)
    v_pk_add_f32 v[48:49], v[48:49], v[124:125]
    v_pk_add_f32 v[50:51], v[50:51], v[126:127]
    s_waitcnt lgkmcnt(6)
    v_pk_add_f32 v[48:49], v[48:49], v[128:129]
    v_pk_add_f32 v[50:51], v[50:51], v[130:131]
    v_pk_add_f32 v[48:49], v[48:49], v[204:205]
    v_pk_add_f32 v[50:51], v[50:51], v[204:205]
    v_cvt_pk_bf16_f32 v162, v48, v49
    v_cvt_pk_bf16_f32 v163, v50, v51
    s_nop 1
    v_permlane16_swap_b32 v160, v162
    v_permlane16_swap_b32 v161, v163
    buffer_store_dwordx4 v[160:163], v7, s[40:43], s77 offen offset:32 sc0 sc1
    s_waitcnt lgkmcnt(5)
    v_pk_add_f32 v[64:65], v[64:65], v[132:133]
    v_pk_add_f32 v[66:67], v[66:67], v[134:135]
    s_waitcnt lgkmcnt(4)
    v_pk_add_f32 v[64:65], v[64:65], v[136:137]
    v_pk_add_f32 v[66:67], v[66:67], v[138:139]
    s_waitcnt lgkmcnt(3)
    v_pk_add_f32 v[64:65], v[64:65], v[140:141]
    v_pk_add_f32 v[66:67], v[66:67], v[142:143]
    v_pk_add_f32 v[64:65], v[64:65], v[204:205]
    v_pk_add_f32 v[66:67], v[66:67], v[204:205]
    v_cvt_pk_bf16_f32 v164, v64, v65
    v_cvt_pk_bf16_f32 v165, v66, v67
    s_waitcnt lgkmcnt(2)
    v_pk_add_f32 v[80:81], v[80:81], v[144:145]
    v_pk_add_f32 v[82:83], v[82:83], v[146:147]
    s_waitcnt lgkmcnt(1)
    v_pk_add_f32 v[80:81], v[80:81], v[148:149]
    v_pk_add_f32 v[82:83], v[82:83], v[150:151]
    s_waitcnt lgkmcnt(0)
    v_pk_add_f32 v[80:81], v[80:81], v[152:153]
    v_pk_add_f32 v[82:83], v[82:83], v[154:155]
    v_pk_add_f32 v[80:81], v[80:81], v[204:205]
    v_pk_add_f32 v[82:83], v[82:83], v[204:205]
    v_cvt_pk_bf16_f32 v166, v80, v81
    v_cvt_pk_bf16_f32 v167, v82, v83
    s_nop 1
    v_permlane16_swap_b32 v164, v166
    v_permlane16_swap_b32 v165, v167
    buffer_store_dwordx4 v[164:167], v7, s[40:43], s77 offen offset:96 sc0 sc1
    s_branch L_fin
L_ep2_1:
    s_cmp_lg_u32 s60, 1
    s_cbranch_scc1 L_ep2_2
    s_waitcnt vmcnt(9)
    s_waitcnt vmcnt(4)
    v_mfma_f32_16x16x32_bf16 v[16:19], v[96:99], a[192:195], v[16:19]
    v_mfma_f32_16x16x32_bf16 v[24:27], v[96:99], a[200:203], v[24:27]
    v_mfma_f32_16x16x32_bf16 v[16:19], v[116:119], a[208:211], v[16:19]
    v_mfma_f32_16x16x32_bf16 v[24:27], v[116:119], a[216:219], v[24:27]
    s_waitcnt vmcnt(3)
    v_mfma_f32_16x16x32_bf16 v[28:31], v[96:99], a[204:207], v[28:31]
    v_mfma_f32_16x16x32_bf16 v[32:35], v[100:103], a[192:195], v[32:35]
    v_mfma_f32_16x16x32_bf16 v[28:31], v[116:119], a[220:223], v[28:31]
    v_mfma_f32_16x16x32_bf16 v[32:35], v[120:123], a[208:211], v[32:35]
    v_mfma_f32_16x16x32_bf16 v[40:43], v[100:103], a[200:203], v[40:43]
    v_mfma_f32_16x16x32_bf16 v[44:47], v[100:103], a[204:207], v[44:47]
    v_mfma_f32_16x16x32_bf16 v[40:43], v[120:123], a[216:219], v[40:43]
    v_mfma_f32_16x16x32_bf16 v[44:47], v[120:123], a[220:223], v[44:47]
    ds_write_b128 v200, v[16:19] offset:32768
    s_waitcnt vmcnt(2)
    v_mfma_f32_16x16x32_bf16 v[48:51], v[104:107], a[192:195], v[48:51]
    ds_write_b128 v200, v[24:27] offset:37888
    v_mfma_f32_16x16x32_bf16 v[56:59], v[104:107], a[200:203], v[56:59]
    ds_write_b128 v200, v[28:31] offset:43008
    v_mfma_f32_16x16x32_bf16 v[48:51], v[124:127], a[208:211], v[48:51]
    ds_write_b128 v200, v[32:35] offset:33792
    v_mfma_f32_16x16x32_bf16 v[56:59], v[124:127], a[216:219], v[56:59]
    ds_write_b128 v200, v[40:43] offset:38912
    s_waitcnt vmcnt(1)
    v_mfma_f32_16x16x32_bf16 v[60:63], v[104:107], a[204:207], v[60:63]
    ds_write_b128 v200, v[44:47] offset:44032
    v_mfma_f32_16x16x32_bf16 v[64:67], v[108:111], a[192:195], v[64:67]
    v_mfma_f32_16x16x32_bf16 v[60:63], v[124:127], a[220:223], v[60:63]
    v_mfma_f32_16x16x32_bf16 v[64:67], v[128:131], a[208:211], v[64:67]
    v_mfma_f32_16x16x32_bf16 v[72:75], v[108:111], a[200:203], v[72:75]
    ds_write_b128 v200, v[48:51] offset:34816
    v_mfma_f32_16x16x32_bf16 v[76:79], v[108:111], a[204:207], v[76:79]
    ds_write_b128 v200, v[56:59] offset:39936
    v_mfma_f32_16x16x32_bf16 v[72:75], v[128:131], a[216:219], v[72:75]
    v_mfma_f32_16x16x32_bf16 v[76:79], v[128:131], a[220:223], v[76:79]
    s_waitcnt vmcnt(0)
    v_mfma_f32_16x16x32_bf16 v[80:83], v[112:115], a[192:195], v[80:83]
    v_mfma_f32_16x16x32_bf16 v[88:91], v[112:115], a[200:203], v[88:91]
    ds_write_b128 v200, v[60:63] offset:45056
    v_mfma_f32_16x16x32_bf16 v[80:83], v[132:135], a[208:211], v[80:83]
    ds_write_b128 v200, v[64:67] offset:35840
    v_mfma_f32_16x16x32_bf16 v[88:91], v[132:135], a[216:219], v[88:91]
    v_mfma_f32_16x16x32_bf16 v[92:95], v[112:115], a[204:207], v[92:95]
    v_mfma_f32_16x16x32_bf16 v[20:23], v[96:99], a[196:199], v[20:23]
    ds_write_b128 v200, v[72:75] offset:40960
    v_mfma_f32_16x16x32_bf16 v[92:95], v[132:135], a[220:223], v[92:95]
    ds_write_b128 v200, v[76:79] offset:46080
    v_mfma_f32_16x16x32_bf16 v[20:23], v[116:119], a[212:215], v[20:23]
    v_mfma_f32_16x16x32_bf16 v[36:39], v[100:103], a[196:199], v[36:39]
    ds_write_b128 v200, v[80:83] offset:36864
    v_mfma_f32_16x16x32_bf16 v[52:55], v[104:107], a[196:199], v[52:55]
    ds_write_b128 v200, v[88:91] offset:41984
    v_mfma_f32_16x16x32_bf16 v[36:39], v[120:123], a[212:215], v[36:39]
    v_mfma_f32_16x16x32_bf16 v[52:55], v[124:127], a[212:215], v[52:55]
    v_mfma_f32_16x16x32_bf16 v[68:71], v[108:111], a[196:199], v[68:71]
    ds_write_b128 v200, v[92:95] offset:47104
    v_mfma_f32_16x16x32_bf16 v[84:87], v[112:115], a[196:199], v[84:87]
    v_mfma_f32_16x16x32_bf16 v[68:71], v[128:131], a[212:215], v[68:71]
    v_mfma_f32_16x16x32_bf16 v[84:87], v[132:135], a[212:215], v[84:87]
    s_waitcnt lgkmcnt(0)
    s_barrier
    s_and_b32 s68, s66, 1
    s_cmp_lg_u32 s68, 0
    s_cbranch_scc1 L_odd_1
    ds_read_b128 v[96:99], v200 offset:0
    ds_read_b128 v[100:103], v201 offset:5120
    ds_read_b128 v[104:107], v201 offset:37888
    ds_read_b128 v[108:111], v200 offset:1024
    ds_read_b128 v[112:115], v201 offset:6144
    ds_read_b128 v[116:119], v201 offset:38912
    ds_read_b128 v[120:123], v200 offset:2048
    ds_read_b128 v[124:127], v201 offset:7168
    ds_read_b128 v[128:131], v201 offset:39936
    ds_read_b128 v[132:135], v200 offset:3072
    ds_read_b128 v[136:139], v201 offset:8192
    ds_read_b128 v[140:143], v201 offset:40960
    ds_read_b128 v[144:147], v200 offset:4096
    ds_read_b128 v[148:151], v201 offset:9216
    ds_read_b128 v[152:155], v201 offset:41984
    s_waitcnt lgkmcnt(14)
    v_pk_add_f32 v[20:21], v[20:21], v[96:97]
    v_pk_add_f32 v[22:23], v[22:23], v[98:99]
    s_waitcnt lgkmcnt(13)
    v_pk_add_f32 v[20:21], v[20:21], v[100:101]
    v_pk_add_f32 v[22:23], v[22:23], v[102:103]
    s_waitcnt lgkmcnt(12)
    v_pk_add_f32 v[20:21], v[20:21], v[104:105]
    v_pk_add_f32 v[22:23], v[22:23], v[106:107]
    v_pk_add_f32 v[20:21], v[20:21], v[204:205]
    v_pk_add_f32 v[22:23], v[22:23], v[204:205]
    v_cvt_pk_bf16_f32 v160, v20, v21
    v_cvt_pk_bf16_f32 v161, v22, v23
    s_waitcnt lgkmcnt(11)
    v_pk_add_f32 v[36:37], v[36:37], v[108:109]
    v_pk_add_f32 v[38:39], v[38:39], v[110:111]
    s_waitcnt lgkmcnt(10)
    v_pk_add_f32 v[36:37], v[36:37], v[112:113]
    v_pk_add_f32 v[38:39], v[38:39], v[114:115]
    s_waitcnt lgkmcnt(9)
    v_pk_add_f32 v[36:37], v[36:37], v[116:117]
    v_pk_add_f32 v[38:39], v[38:39], v[118:119]
    v_pk_add_f32 v[36:37], v[36:37], v[204:205]
    v_pk_add_f32 v[38:39], v[38:39], v[204:205]
    v_cvt_pk_bf16_f32 v162, v36, v37
    v_cvt_pk_bf16_f32 v163, v38, v39
    s_nop 1
    v_permlane16_swap_b32 v160, v162
    v_permlane16_swap_b32 v161, v163
    buffer_store_dwordx4 v[160:163], v7, s[40:43], s77 offen offset:0 sc0 sc1
    s_waitcnt lgkmcnt(8)
    v_pk_add_f32 v[52:53], v[52:53], v[120:121]
    v_pk_add_f32 v[54:55], v[54:55], v[122:123]
    s_waitcnt lgkmcnt(7)
    v_pk_add_f32 v[52:53], v[52:53], v[124:125]
    v_pk_add_f32 v[54:55], v[54:55], v[126:127]
    s_waitcnt lgkmcnt(6)
    v_pk_add_f32 v[52:53], v[52:53], v[128:129]
    v_pk_add_f32 v[54:55], v[54:55], v[130:131]
    v_pk_add_f32 v[52:53], v[52:53], v[204:205]
    v_pk_add_f32 v[54:55], v[54:55], v[204:205]
    v_cvt_pk_bf16_f32 v164, v52, v53
    v_cvt_pk_bf16_f32 v165, v54, v55
    s_waitcnt lgkmcnt(5)
    v_pk_add_f32 v[68:69], v[68:69], v[132:133]
    v_pk_add_f32 v[70:71], v[70:71], v[134:135]
    s_waitcnt lgkmcnt(4)
    v_pk_add_f32 v[68:69], v[68:69], v[136:137]
    v_pk_add_f32 v[70:71], v[70:71], v[138:139]
    s_waitcnt lgkmcnt(3)
    v_pk_add_f32 v[68:69], v[68:69], v[140:141]
    v_pk_add_f32 v[70:71], v[70:71], v[142:143]
    v_pk_add_f32 v[68:69], v[68:69], v[204:205]
    v_pk_add_f32 v[70:71], v[70:71], v[204:205]
    v_cvt_pk_bf16_f32 v166, v68, v69
    v_cvt_pk_bf16_f32 v167, v70, v71
    s_nop 1
    v_permlane16_swap_b32 v164, v166
    v_permlane16_swap_b32 v165, v167
    buffer_store_dwordx4 v[164:167], v7, s[40:43], s77 offen offset:64 sc0 sc1
    s_waitcnt lgkmcnt(2)
    v_pk_add_f32 v[84:85], v[84:85], v[144:145]
    v_pk_add_f32 v[86:87], v[86:87], v[146:147]
    s_waitcnt lgkmcnt(1)
    v_pk_add_f32 v[84:85], v[84:85], v[148:149]
    v_pk_add_f32 v[86:87], v[86:87], v[150:151]
    s_waitcnt lgkmcnt(0)
    v_pk_add_f32 v[84:85], v[84:85], v[152:153]
    v_pk_add_f32 v[86:87], v[86:87], v[154:155]
    v_pk_add_f32 v[84:85], v[84:85], v[204:205]
    v_pk_add_f32 v[86:87], v[86:87], v[204:205]
    v_cvt_pk_bf16_f32 v168, v84, v85
    v_cvt_pk_bf16_f32 v169, v86, v87
    buffer_store_dwordx2 v[168:169], v6, s[40:43], s77 offen offset:128 sc0 sc1
    s_branch L_fin
L_odd_1:
    ds_read_b128 v[96:99], v200 offset:0
    ds_read_b128 v[100:103], v201 offset:5120
    ds_read_b128 v[104:107], v201 offset:37888
    ds_read_b128 v[108:111], v200 offset:1024
    ds_read_b128 v[112:115], v201 offset:6144
    ds_read_b128 v[116:119], v201 offset:38912
    ds_read_b128 v[120:123], v200 offset:2048
    ds_read_b128 v[124:127], v201 offset:7168
    ds_read_b128 v[128:131], v201 offset:39936
    ds_read_b128 v[132:135], v200 offset:3072
    ds_read_b128 v[136:139], v201 offset:8192
    ds_read_b128 v[140:143], v201 offset:40960
    ds_read_b128 v[144:147], v200 offset:4096
    ds_read_b128 v[148:151], v201 offset:9216
    ds_read_b128 v[152:155], v201 offset:41984
    s_waitcnt lgkmcnt(14)
    v_pk_add_f32 v[20:21], v[20:21], v[96:97]
    v_pk_add_f32 v[22:23], v[22:23], v[98:99]
    s_waitcnt lgkmcnt(13)
    v_pk_add_f32 v[20:21], v[20:21], v[100:101]
    v_pk_add_f32 v[22:23], v[22:23], v[102:103]
    s_waitcnt lgkmcnt(12)
    v_pk_add_f32 v[20:21], v[20:21], v[104:105]
    v_pk_add_f32 v[22:23], v[22:23], v[106:107]
    v_pk_add_f32 v[20:21], v[20:21], v[204:205]
    v_pk_add_f32 v[22:23], v[22:23], v[204:205]
    v_cvt_pk_bf16_f32 v168, v20, v21
    v_cvt_pk_bf16_f32 v169, v22, v23
    buffer_store_dwordx2 v[168:169], v6, s[40:43], s77 offen offset:0 sc0 sc1
    s_waitcnt lgkmcnt(11)
    v_pk_add_f32 v[36:37], v[36:37], v[108:109]
    v_pk_add_f32 v[38:39], v[38:39], v[110:111]
    s_waitcnt lgkmcnt(10)
    v_pk_add_f32 v[36:37], v[36:37], v[112:113]
    v_pk_add_f32 v[38:39], v[38:39], v[114:115]
    s_waitcnt lgkmcnt(9)
    v_pk_add_f32 v[36:37], v[36:37], v[116:117]
    v_pk_add_f32 v[38:39], v[38:39], v[118:119]
    v_pk_add_f32 v[36:37], v[36:37], v[204:205]
    v_pk_add_f32 v[38:39], v[38:39], v[204:205]
    v_cvt_pk_bf16_f32 v160, v36, v37
    v_cvt_pk_bf16_f32 v161, v38, v39
    s_waitcnt lgkmcnt(8)
    v_pk_add_f32 v[52:53], v[52:53], v[120:121]
    v_pk_add_f32 v[54:55], v[54:55], v[122:123]
    s_waitcnt lgkmcnt(7)
    v_pk_add_f32 v[52:53], v[52:53], v[124:125]
    v_pk_add_f32 v[54:55], v[54:55], v[126:127]
    s_waitcnt lgkmcnt(6)
    v_pk_add_f32 v[52:53], v[52:53], v[128:129]
    v_pk_add_f32 v[54:55], v[54:55], v[130:131]
    v_pk_add_f32 v[52:53], v[52:53], v[204:205]
    v_pk_add_f32 v[54:55], v[54:55], v[204:205]
    v_cvt_pk_bf16_f32 v162, v52, v53
    v_cvt_pk_bf16_f32 v163, v54, v55
    s_nop 1
    v_permlane16_swap_b32 v160, v162
    v_permlane16_swap_b32 v161, v163
    buffer_store_dwordx4 v[160:163], v7, s[40:43], s77 offen offset:32 sc0 sc1
    s_waitcnt lgkmcnt(5)
    v_pk_add_f32 v[68:69], v[68:69], v[132:133]
    v_pk_add_f32 v[70:71], v[70:71], v[134:135]
    s_waitcnt lgkmcnt(4)
    v_pk_add_f32 v[68:69], v[68:69], v[136:137]
    v_pk_add_f32 v[70:71], v[70:71], v[138:139]
    s_waitcnt lgkmcnt(3)
    v_pk_add_f32 v[68:69], v[68:69], v[140:141]
    v_pk_add_f32 v[70:71], v[70:71], v[142:143]
    v_pk_add_f32 v[68:69], v[68:69], v[204:205]
    v_pk_add_f32 v[70:71], v[70:71], v[204:205]
    v_cvt_pk_bf16_f32 v164, v68, v69
    v_cvt_pk_bf16_f32 v165, v70, v71
    s_waitcnt lgkmcnt(2)
    v_pk_add_f32 v[84:85], v[84:85], v[144:145]
    v_pk_add_f32 v[86:87], v[86:87], v[146:147]
    s_waitcnt lgkmcnt(1)
    v_pk_add_f32 v[84:85], v[84:85], v[148:149]
    v_pk_add_f32 v[86:87], v[86:87], v[150:151]
    s_waitcnt lgkmcnt(0)
    v_pk_add_f32 v[84:85], v[84:85], v[152:153]
    v_pk_add_f32 v[86:87], v[86:87], v[154:155]
    v_pk_add_f32 v[84:85], v[84:85], v[204:205]
    v_pk_add_f32 v[86:87], v[86:87], v[204:205]
    v_cvt_pk_bf16_f32 v166, v84, v85
    v_cvt_pk_bf16_f32 v167, v86, v87
    s_nop 1
    v_permlane16_swap_b32 v164, v166
    v_permlane16_swap_b32 v165, v167
    buffer_store_dwordx4 v[164:167], v7, s[40:43], s77 offen offset:96 sc0 sc1
    s_branch L_fin
L_ep2_2:
    s_cmp_lg_u32 s60, 2
    s_cbranch_scc1 L_ep2_3
    s_waitcnt vmcnt(9)
    s_waitcnt vmcnt(4)
    v_mfma_f32_16x16x32_bf16 v[16:19], v[96:99], a[192:195], v[16:19]
    v_mfma_f32_16x16x32_bf16 v[20:23], v[96:99], a[196:199], v[20:23]
    v_mfma_f32_16x16x32_bf16 v[16:19], v[116:119], a[208:211], v[16:19]
    v_mfma_f32_16x16x32_bf16 v[20:23], v[116:119], a[212:215], v[20:23]
    s_waitcnt vmcnt(3)
    v_mfma_f32_16x16x32_bf16 v[28:31], v[96:99], a[204:207], v[28:31]
    v_mfma_f32_16x16x32_bf16 v[32:35], v[100:103], a[192:195], v[32:35]
    v_mfma_f32_16x16x32_bf16 v[28:31], v[116:119], a[220:223], v[28:31]
    v_mfma_f32_16x16x32_bf16 v[32:35], v[120:123], a[208:211], v[32:35]
    v_mfma_f32_16x16x32_bf16 v[36:39], v[100:103], a[196:199], v[36:39]
    v_mfma_f32_16x16x32_bf16 v[44:47], v[100:103], a[204:207], v[44:47]
    v_mfma_f32_16x16x32_bf16 v[36:39], v[120:123], a[212:215], v[36:39]
    v_mfma_f32_16x16x32_bf16 v[44:47], v[120:123], a[220:223], v[44:47]
    ds_write_b128 v201, v[16:19] offset:0
    s_waitcnt vmcnt(2)
    v_mfma_f32_16x16x32_bf16 v[48:51], v[104:107], a[192:195], v[48:51]
    ds_write_b128 v201, v[20:23] offset:5120
    v_mfma_f32_16x16x32_bf16 v[52:55], v[104:107], a[196:199], v[52:55]
    ds_write_b128 v201, v[28:31] offset:10240
    v_mfma_f32_16x16x32_bf16 v[48:51], v[124:127], a[208:211], v[48:51]
    ds_write_b128 v201, v[32:35] offset:1024
    v_mfma_f32_16x16x32_bf16 v[52:55], v[124:127], a[212:215], v[52:55]
    ds_write_b128 v201, v[36:39] offset:6144
    s_waitcnt vmcnt(1)
    v_mfma_f32_16x16x32_bf16 v[60:63], v[104:107], a[204:207], v[60:63]
    ds_write_b128 v201, v[44:47] offset:11264
    v_mfma_f32_16x16x32_bf16 v[64:67], v[108:111], a[192:195], v[64:67]
    v_mfma_f32_16x16x32_bf16 v[60:63], v[124:127], a[220:223], v[60:63]
    v_mfma_f32_16x16x32_bf16 v[64:67], v[128:131], a[208:211], v[64:67]
    v_mfma_f32_16x16x32_bf16 v[68:71], v[108:111], a[196:199], v[68:71]
    ds_write_b128 v201, v[48:51] offset:2048
    v_mfma_f32_16x16x32_bf16 v[76:79], v[108:111], a[204:207], v[76:79]
    ds_write_b128 v201, v[52:55] offset:7168
    v_mfma_f32_16x16x32_bf16 v[68:71], v[128:131], a[212:215], v[68:71]
    v_mfma_f32_16x16x32_bf16 v[76:79], v[128:131], a[220:223], v[76:79]
    s_waitcnt vmcnt(0)
    v_mfma_f32_16x16x32_bf16 v[80:83], v[112:115], a[192:195], v[80:83]
    v_mfma_f32_16x16x32_bf16 v[84:87], v[112:115], a[196:199], v[84:87]
    ds_write_b128 v201, v[60:63] offset:12288
    v_mfma_f32_16x16x32_bf16 v[80:83], v[132:135], a[208:211], v[80:83]
    ds_write_b128 v201, v[64:67] offset:3072
    v_mfma_f32_16x16x32_bf16 v[84:87], v[132:135], a[212:215], v[84:87]
    v_mfma_f32_16x16x32_bf16 v[92:95], v[112:115], a[204:207], v[92:95]
    v_mfma_f32_16x16x32_bf16 v[24:27], v[96:99], a[200:203], v[24:27]
    ds_write_b128 v201, v[68:71] offset:8192
    v_mfma_f32_16x16x32_bf16 v[92:95], v[132:135], a[220:223], v[92:95]
    ds_write_b128 v201, v[76:79] offset:13312
    v_mfma_f32_16x16x32_bf16 v[24:27], v[116:119], a[216:219], v[24:27]
    v_mfma_f32_16x16x32_bf16 v[40:43], v[100:103], a[200:203], v[40:43]
    ds_write_b128 v201, v[80:83] offset:4096
    v_mfma_f32_16x16x32_bf16 v[56:59], v[104:107], a[200:203], v[56:59]
    ds_write_b128 v201, v[84:87] offset:9216
    v_mfma_f32_16x16x32_bf16 v[40:43], v[120:123], a[216:219], v[40:43]
    v_mfma_f32_16x16x32_bf16 v[56:59], v[124:127], a[216:219], v[56:59]
    v_mfma_f32_16x16x32_bf16 v[72:75], v[108:111], a[200:203], v[72:75]
    ds_write_b128 v201, v[92:95] offset:14336
    v_mfma_f32_16x16x32_bf16 v[88:91], v[112:115], a[200:203], v[88:91]
    v_mfma_f32_16x16x32_bf16 v[72:75], v[128:131], a[216:219], v[72:75]
    v_mfma_f32_16x16x32_bf16 v[88:91], v[132:135], a[216:219], v[88:91]
    s_waitcnt lgkmcnt(0)
    s_barrier
    s_and_b32 s68, s66, 1
    s_cmp_lg_u32 s68, 0
    s_cbranch_scc1 L_odd_2
    ds_read_b128 v[96:99], v200 offset:5120
    ds_read_b128 v[100:103], v200 offset:37888
    ds_read_b128 v[104:107], v201 offset:43008
    ds_read_b128 v[108:111], v200 offset:6144
    ds_read_b128 v[112:115], v200 offset:38912
    ds_read_b128 v[116:119], v201 offset:44032
    ds_read_b128 v[120:123], v200 offset:7168
    ds_read_b128 v[124:127], v200 offset:39936
    ds_read_b128 v[128:131], v201 offset:45056
    ds_read_b128 v[132:135], v200 offset:8192
    ds_read_b128 v[136:139], v200 offset:40960
    ds_read_b128 v[140:143], v201 offset:46080
    ds_read_b128 v[144:147], v200 offset:9216
    ds_read_b128 v[148:151], v200 offset:41984
    ds_read_b128 v[152:155], v201 offset:47104
    s_waitcnt lgkmcnt(14)
    v_pk_add_f32 v[24:25], v[24:25], v[96:97]
    v_pk_add_f32 v[26:27], v[26:27], v[98:99]
    s_waitcnt lgkmcnt(13)
    v_pk_add_f32 v[24:25], v[24:25], v[100:101]
    v_pk_add_f32 v[26:27], v[26:27], v[102:103]
    s_waitcnt lgkmcnt(12)
    v_pk_add_f32 v[24:25], v[24:25], v[104:105]
    v_pk_add_f32 v[26:27], v[26:27], v[106:107]
    v_pk_add_f32 v[24:25], v[24:25], v[204:205]
    v_pk_add_f32 v[26:27], v[26:27], v[204:205]
    v_cvt_pk_bf16_f32 v160, v24, v25
    v_cvt_pk_bf16_f32 v161, v26, v27
    s_waitcnt lgkmcnt(11)
    v_pk_add_f32 v[40:41], v[40:41], v[108:109]
    v_pk_add_f32 v[42:43], v[42:43], v[110:111]
    s_waitcnt lgkmcnt(10)
    v_pk_add_f32 v[40:41], v[40:41], v[112:113]
    v_pk_add_f32 v[42:43], v[42:43], v[114:115]
    s_waitcnt lgkmcnt(9)
    v_pk_add_f32 v[40:41], v[40:41], v[116:117]
    v_pk_add_f32 v[42:43], v[42:43], v[118:119]
    v_pk_add_f32 v[40:41], v[40:41], v[204:205]
    v_pk_add_f32 v[42:43], v[42:43], v[204:205]
    v_cvt_pk_bf16_f32 v162, v40, v41
    v_cvt_pk_bf16_f32 v163, v42, v43
    s_nop 1
    v_permlane16_swap_b32 v160, v162
    v_permlane16_swap_b32 v161, v163
    buffer_store_dwordx4 v[160:163], v7, s[40:43], s77 offen offset:0 sc0 sc1
    s_waitcnt lgkmcnt(8)
    v_pk_add_f32 v[56:57], v[56:57], v[120:121]
    v_pk_add_f32 v[58:59], v[58:59], v[122:123]
    s_waitcnt lgkmcnt(7)
    v_pk_add_f32 v[56:57], v[56:57], v[124:125]
    v_pk_add_f32 v[58:59], v[58:59], v[126:127]
    s_waitcnt lgkmcnt(6)
    v_pk_add_f32 v[56:57], v[56:57], v[128:129]
    v_pk_add_f32 v[58:59], v[58:59], v[130:131]
    v_pk_add_f32 v[56:57], v[56:57], v[204:205]
    v_pk_add_f32 v[58:59], v[58:59], v[204:205]
    v_cvt_pk_bf16_f32 v164, v56, v57
    v_cvt_pk_bf16_f32 v165, v58, v59
    s_waitcnt lgkmcnt(5)
    v_pk_add_f32 v[72:73], v[72:73], v[132:133]
    v_pk_add_f32 v[74:75], v[74:75], v[134:135]
    s_waitcnt lgkmcnt(4)
    v_pk_add_f32 v[72:73], v[72:73], v[136:137]
    v_pk_add_f32 v[74:75], v[74:75], v[138:139]
    s_waitcnt lgkmcnt(3)
    v_pk_add_f32 v[72:73], v[72:73], v[140:141]
    v_pk_add_f32 v[74:75], v[74:75], v[142:143]
    v_pk_add_f32 v[72:73], v[72:73], v[204:205]
    v_pk_add_f32 v[74:75], v[74:75], v[204:205]
    v_cvt_pk_bf16_f32 v166, v72, v73
    v_cvt_pk_bf16_f32 v167, v74, v75
    s_nop 1
    v_permlane16_swap_b32 v164, v166
    v_permlane16_swap_b32 v165, v167
    buffer_store_dwordx4 v[164:167], v7, s[40:43], s77 offen offset:64 sc0 sc1
    s_waitcnt lgkmcnt(2)
    v_pk_add_f32 v[88:89], v[88:89], v[144:145]
    v_pk_add_f32 v[90:91], v[90:91], v[146:147]
    s_waitcnt lgkmcnt(1)
    v_pk_add_f32 v[88:89], v[88:89], v[148:149]
    v_pk_add_f32 v[90:91], v[90:91], v[150:151]
    s_waitcnt lgkmcnt(0)
    v_pk_add_f32 v[88:89], v[88:89], v[152:153]
    v_pk_add_f32 v[90:91], v[90:91], v[154:155]
    v_pk_add_f32 v[88:89], v[88:89], v[204:205]
    v_pk_add_f32 v[90:91], v[90:91], v[204:205]
    v_cvt_pk_bf16_f32 v168, v88, v89
    v_cvt_pk_bf16_f32 v169, v90, v91
    buffer_store_dwordx2 v[168:169], v6, s[40:43], s77 offen offset:128 sc0 sc1
    s_branch L_fin
L_odd_2:
    ds_read_b128 v[96:99], v200 offset:5120
    ds_read_b128 v[100:103], v200 offset:37888
    ds_read_b128 v[104:107], v201 offset:43008
    ds_read_b128 v[108:111], v200 offset:6144
    ds_read_b128 v[112:115], v200 offset:38912
    ds_read_b128 v[116:119], v201 offset:44032
    ds_read_b128 v[120:123], v200 offset:7168
    ds_read_b128 v[124:127], v200 offset:39936
    ds_read_b128 v[128:131], v201 offset:45056
    ds_read_b128 v[132:135], v200 offset:8192
    ds_read_b128 v[136:139], v200 offset:40960
    ds_read_b128 v[140:143], v201 offset:46080
    ds_read_b128 v[144:147], v200 offset:9216
    ds_read_b128 v[148:151], v200 offset:41984
    ds_read_b128 v[152:155], v201 offset:47104
    s_waitcnt lgkmcnt(14)
    v_pk_add_f32 v[24:25], v[24:25], v[96:97]
    v_pk_add_f32 v[26:27], v[26:27], v[98:99]
    s_waitcnt lgkmcnt(13)
    v_pk_add_f32 v[24:25], v[24:25], v[100:101]
    v_pk_add_f32 v[26:27], v[26:27], v[102:103]
    s_waitcnt lgkmcnt(12)
    v_pk_add_f32 v[24:25], v[24:25], v[104:105]
    v_pk_add_f32 v[26:27], v[26:27], v[106:107]
    v_pk_add_f32 v[24:25], v[24:25], v[204:205]
    v_pk_add_f32 v[26:27], v[26:27], v[204:205]
    v_cvt_pk_bf16_f32 v168, v24, v25
    v_cvt_pk_bf16_f32 v169, v26, v27
    buffer_store_dwordx2 v[168:169], v6, s[40:43], s77 offen offset:0 sc0 sc1
    s_waitcnt lgkmcnt(11)
    v_pk_add_f32 v[40:41], v[40:41], v[108:109]
    v_pk_add_f32 v[42:43], v[42:43], v[110:111]
    s_waitcnt lgkmcnt(10)
    v_pk_add_f32 v[40:41], v[40:41], v[112:113]
    v_pk_add_f32 v[42:43], v[42:43], v[114:115]
    s_waitcnt lgkmcnt(9)
    v_pk_add_f32 v[40:41], v[40:41], v[116:117]
    v_pk_add_f32 v[42:43], v[42:43], v[118:119]
    v_pk_add_f32 v[40:41], v[40:41], v[204:205]
    v_pk_add_f32 v[42:43], v[42:43], v[204:205]
    v_cvt_pk_bf16_f32 v160, v40, v41
    v_cvt_pk_bf16_f32 v161, v42, v43
    s_waitcnt lgkmcnt(8)
    v_pk_add_f32 v[56:57], v[56:57], v[120:121]
    v_pk_add_f32 v[58:59], v[58:59], v[122:123]
    s_waitcnt lgkmcnt(7)
    v_pk_add_f32 v[56:57], v[56:57], v[124:125]
    v_pk_add_f32 v[58:59], v[58:59], v[126:127]
    s_waitcnt lgkmcnt(6)
    v_pk_add_f32 v[56:57], v[56:57], v[128:129]
    v_pk_add_f32 v[58:59], v[58:59], v[130:131]
    v_pk_add_f32 v[56:57], v[56:57], v[204:205]
    v_pk_add_f32 v[58:59], v[58:59], v[204:205]
    v_cvt_pk_bf16_f32 v162, v56, v57
    v_cvt_pk_bf16_f32 v163, v58, v59
    s_nop 1
    v_permlane16_swap_b32 v160, v162
    v_permlane16_swap_b32 v161, v163
    buffer_store_dwordx4 v[160:163], v7, s[40:43], s77 offen offset:32 sc0 sc1
    s_waitcnt lgkmcnt(5)
    v_pk_add_f32 v[72:73], v[72:73], v[132:133]
    v_pk_add_f32 v[74:75], v[74:75], v[134:135]
    s_waitcnt lgkmcnt(4)
    v_pk_add_f32 v[72:73], v[72:73], v[136:137]
    v_pk_add_f32 v[74:75], v[74:75], v[138:139]
    s_waitcnt lgkmcnt(3)
    v_pk_add_f32 v[72:73], v[72:73], v[140:141]
    v_pk_add_f32 v[74:75], v[74:75], v[142:143]
    v_pk_add_f32 v[72:73], v[72:73], v[204:205]
    v_pk_add_f32 v[74:75], v[74:75], v[204:205]
    v_cvt_pk_bf16_f32 v164, v72, v73
    v_cvt_pk_bf16_f32 v165, v74, v75
    s_waitcnt lgkmcnt(2)
    v_pk_add_f32 v[88:89], v[88:89], v[144:145]
    v_pk_add_f32 v[90:91], v[90:91], v[146:147]
    s_waitcnt lgkmcnt(1)
    v_pk_add_f32 v[88:89], v[88:89], v[148:149]
    v_pk_add_f32 v[90:91], v[90:91], v[150:151]
    s_waitcnt lgkmcnt(0)
    v_pk_add_f32 v[88:89], v[88:89], v[152:153]
    v_pk_add_f32 v[90:91], v[90:91], v[154:155]
    v_pk_add_f32 v[88:89], v[88:89], v[204:205]
    v_pk_add_f32 v[90:91], v[90:91], v[204:205]
    v_cvt_pk_bf16_f32 v166, v88, v89
    v_cvt_pk_bf16_f32 v167, v90, v91
    s_nop 1
    v_permlane16_swap_b32 v164, v166
    v_permlane16_swap_b32 v165, v167
    buffer_store_dwordx4 v[164:167], v7, s[40:43], s77 offen offset:96 sc0 sc1
    s_branch L_fin
L_ep2_3:
    s_waitcnt vmcnt(9)
    s_waitcnt vmcnt(4)
    v_mfma_f32_16x16x32_bf16 v[16:19], v[96:99], a[192:195], v[16:19]
    v_mfma_f32_16x16x32_bf16 v[20:23], v[96:99], a[196:199], v[20:23]
    v_mfma_f32_16x16x32_bf16 v[16:19], v[116:119], a[208:211], v[16:19]
    v_mfma_f32_16x16x32_bf16 v[20:23], v[116:119], a[212:215], v[20:23]
    s_waitcnt vmcnt(3)
    v_mfma_f32_16x16x32_bf16 v[24:27], v[96:99], a[200:203], v[24:27]
    v_mfma_f32_16x16x32_bf16 v[32:35], v[100:103], a[192:195], v[32:35]
    v_mfma_f32_16x16x32_bf16 v[24:27], v[116:119], a[216:219], v[24:27]
    v_mfma_f32_16x16x32_bf16 v[32:35], v[120:123], a[208:211], v[32:35]
    v_mfma_f32_16x16x32_bf16 v[36:39], v[100:103], a[196:199], v[36:39]
    v_mfma_f32_16x16x32_bf16 v[40:43], v[100:103], a[200:203], v[40:43]
    v_mfma_f32_16x16x32_bf16 v[36:39], v[120:123], a[212:215], v[36:39]
    v_mfma_f32_16x16x32_bf16 v[40:43], v[120:123], a[216:219], v[40:43]
    ds_write_b128 v201, v[16:19] offset:32768
    s_waitcnt vmcnt(2)
    v_mfma_f32_16x16x32_bf16 v[48:51], v[104:107], a[192:195], v[48:51]
    ds_write_b128 v201, v[20:23] offset:37888
    v_mfma_f32_16x16x32_bf16 v[52:55], v[104:107], a[196:199], v[52:55]
    ds_write_b128 v201, v[24:27] offset:43008
    v_mfma_f32_16x16x32_bf16 v[48:51], v[124:127], a[208:211], v[48:51]
    ds_write_b128 v201, v[32:35] offset:33792
    v_mfma_f32_16x16x32_bf16 v[52:55], v[124:127], a[212:215], v[52:55]
    ds_write_b128 v201, v[36:39] offset:38912
    s_waitcnt vmcnt(1)
    v_mfma_f32_16x16x32_bf16 v[56:59], v[104:107], a[200:203], v[56:59]
    ds_write_b128 v201, v[40:43] offset:44032
    v_mfma_f32_16x16x32_bf16 v[64:67], v[108:111], a[192:195], v[64:67]
    v_mfma_f32_16x16x32_bf16 v[56:59], v[124:127], a[216:219], v[56:59]
    v_mfma_f32_16x16x32_bf16 v[64:67], v[128:131], a[208:211], v[64:67]
    v_mfma_f32_16x16x32_bf16 v[68:71], v[108:111], a[196:199], v[68:71]
    ds_write_b128 v201, v[48:51] offset:34816
    v_mfma_f32_16x16x32_bf16 v[72:75], v[108:111], a[200:203], v[72:75]
    ds_write_b128 v201, v[52:55] offset:39936
    v_mfma_f32_16x16x32_bf16 v[68:71], v[128:131], a[212:215], v[68:71]
    v_mfma_f32_16x16x32_bf16 v[72:75], v[128:131], a[216:219], v[72:75]
    s_waitcnt vmcnt(0)
    v_mfma_f32_16x16x32_bf16 v[80:83], v[112:115], a[192:195], v[80:83]
    v_mfma_f32_16x16x32_bf16 v[84:87], v[112:115], a[196:199], v[84:87]
    ds_write_b128 v201, v[56:59] offset:45056
    v_mfma_f32_16x16x32_bf16 v[80:83], v[132:135], a[208:211], v[80:83]
    ds_write_b128 v201, v[64:67] offset:35840
    v_mfma_f32_16x16x32_bf16 v[84:87], v[132:135], a[212:215], v[84:87]
    v_mfma_f32_16x16x32_bf16 v[88:91], v[112:115], a[200:203], v[88:91]
    v_mfma_f32_16x16x32_bf16 v[28:31], v[96:99], a[204:207], v[28:31]
    ds_write_b128 v201, v[68:71] offset:40960
    v_mfma_f32_16x16x32_bf16 v[88:91], v[132:135], a[216:219], v[88:91]
    ds_write_b128 v201, v[72:75] offset:46080
    v_mfma_f32_16x16x32_bf16 v[28:31], v[116:119], a[220:223], v[28:31]
    v_mfma_f32_16x16x32_bf16 v[44:47], v[100:103], a[204:207], v[44:47]
    ds_write_b128 v201, v[80:83] offset:36864
    v_mfma_f32_16x16x32_bf16 v[60:63], v[104:107], a[204:207], v[60:63]
    ds_write_b128 v201, v[84:87] offset:41984
    v_mfma_f32_16x16x32_bf16 v[44:47], v[120:123], a[220:223], v[44:47]
    v_mfma_f32_16x16x32_bf16 v[60:63], v[124:127], a[220:223], v[60:63]
    v_mfma_f32_16x16x32_bf16 v[76:79], v[108:111], a[204:207], v[76:79]
    ds_write_b128 v201, v[88:91] offset:47104
    v_mfma_f32_16x16x32_bf16 v[92:95], v[112:115], a[204:207], v[92:95]
    v_mfma_f32_16x16x32_bf16 v[76:79], v[128:131], a[220:223], v[76:79]
    v_mfma_f32_16x16x32_bf16 v[92:95], v[132:135], a[220:223], v[92:95]
    s_waitcnt lgkmcnt(0)
    s_barrier
    s_and_b32 s68, s66, 1
    s_cmp_lg_u32 s68, 0
    s_cbranch_scc1 L_odd_3
    ds_read_b128 v[96:99], v200 offset:10240
    ds_read_b128 v[100:103], v200 offset:43008
    ds_read_b128 v[104:107], v201 offset:10240
    ds_read_b128 v[108:111], v200 offset:11264
    ds_read_b128 v[112:115], v200 offset:44032
    ds_read_b128 v[116:119], v201 offset:11264
    ds_read_b128 v[120:123], v200 offset:12288
    ds_read_b128 v[124:127], v200 offset:45056
    ds_read_b128 v[128:131], v201 offset:12288
    ds_read_b128 v[132:135], v200 offset:13312
    ds_read_b128 v[136:139], v200 offset:46080
    ds_read_b128 v[140:143], v201 offset:13312
    ds_read_b128 v[144:147], v200 offset:14336
    ds_read_b128 v[148:151], v200 offset:47104
    ds_read_b128 v[152:155], v201 offset:14336
    s_waitcnt lgkmcnt(14)
    v_pk_add_f32 v[28:29], v[28:29], v[96:97]
    v_pk_add_f32 v[30:31], v[30:31], v[98:99]
    s_waitcnt lgkmcnt(13)
    v_pk_add_f32 v[28:29], v[28:29], v[100:101]
    v_pk_add_f32 v[30:31], v[30:31], v[102:103]
    s_waitcnt lgkmcnt(12)
    v_pk_add_f32 v[28:29], v[28:29], v[104:105]
    v_pk_add_f32 v[30:31], v[30:31], v[106:107]
    v_pk_add_f32 v[28:29], v[28:29], v[204:205]
    v_pk_add_f32 v[30:31], v[30:31], v[204:205]
    v_cvt_pk_bf16_f32 v160, v28, v29
    v_cvt_pk_bf16_f32 v161, v30, v31
    s_waitcnt lgkmcnt(11)
    v_pk_add_f32 v[44:45], v[44:45], v[108:109]
    v_pk_add_f32 v[46:47], v[46:47], v[110:111]
    s_waitcnt lgkmcnt(10)
    v_pk_add_f32 v[44:45], v[44:45], v[112:113]
    v_pk_add_f32 v[46:47], v[46:47], v[114:115]
    s_waitcnt lgkmcnt(9)
    v_pk_add_f32 v[44:45], v[44:45], v[116:117]
    v_pk_add_f32 v[46:47], v[46:47], v[118:119]
    v_pk_add_f32 v[44:45], v[44:45], v[204:205]
    v_pk_add_f32 v[46:47], v[46:47], v[204:205]
    v_cvt_pk_bf16_f32 v162, v44, v45
    v_cvt_pk_bf16_f32 v163, v46, v47
    s_nop 1
    v_permlane16_swap_b32 v160, v162
    v_permlane16_swap_b32 v161, v163
    buffer_store_dwordx4 v[160:163], v7, s[40:43], s77 offen offset:0 sc0 sc1
    s_waitcnt lgkmcnt(8)
    v_pk_add_f32 v[60:61], v[60:61], v[120:121]
    v_pk_add_f32 v[62:63], v[62:63], v[122:123]
    s_waitcnt lgkmcnt(7)
    v_pk_add_f32 v[60:61], v[60:61], v[124:125]
    v_pk_add_f32 v[62:63], v[62:63], v[126:127]
    s_waitcnt lgkmcnt(6)
    v_pk_add_f32 v[60:61], v[60:61], v[128:129]
    v_pk_add_f32 v[62:63], v[62:63], v[130:131]
    v_pk_add_f32 v[60:61], v[60:61], v[204:205]
    v_pk_add_f32 v[62:63], v[62:63], v[204:205]
    v_cvt_pk_bf16_f32 v164, v60, v61
    v_cvt_pk_bf16_f32 v165, v62, v63
    s_waitcnt lgkmcnt(5)
    v_pk_add_f32 v[76:77], v[76:77], v[132:133]
    v_pk_add_f32 v[78:79], v[78:79], v[134:135]
    s_waitcnt lgkmcnt(4)
    v_pk_add_f32 v[76:77], v[76:77], v[136:137]
    v_pk_add_f32 v[78:79], v[78:79], v[138:139]
    s_waitcnt lgkmcnt(3)
    v_pk_add_f32 v[76:77], v[76:77], v[140:141]
    v_pk_add_f32 v[78:79], v[78:79], v[142:143]
    v_pk_add_f32 v[76:77], v[76:77], v[204:205]
    v_pk_add_f32 v[78:79], v[78:79], v[204:205]
    v_cvt_pk_bf16_f32 v166, v76, v77
    v_cvt_pk_bf16_f32 v167, v78, v79
    s_nop 1
    v_permlane16_swap_b32 v164, v166
    v_permlane16_swap_b32 v165, v167
    buffer_store_dwordx4 v[164:167], v7, s[40:43], s77 offen offset:64 sc0 sc1
    s_waitcnt lgkmcnt(2)
    v_pk_add_f32 v[92:93], v[92:93], v[144:145]
    v_pk_add_f32 v[94:95], v[94:95], v[146:147]
    s_waitcnt lgkmcnt(1)
    v_pk_add_f32 v[92:93], v[92:93], v[148:149]
    v_pk_add_f32 v[94:95], v[94:95], v[150:151]
    s_waitcnt lgkmcnt(0)
    v_pk_add_f32 v[92:93], v[92:93], v[152:153]
    v_pk_add_f32 v[94:95], v[94:95], v[154:155]
    v_pk_add_f32 v[92:93], v[92:93], v[204:205]
    v_pk_add_f32 v[94:95], v[94:95], v[204:205]
    v_cvt_pk_bf16_f32 v168, v92, v93
    v_cvt_pk_bf16_f32 v169, v94, v95
    buffer_store_dwordx2 v[168:169], v6, s[40:43], s77 offen offset:128 sc0 sc1
    s_branch L_fin
L_odd_3:
    ds_read_b128 v[96:99], v200 offset:10240
    ds_read_b128 v[100:103], v200 offset:43008
    ds_read_b128 v[104:107], v201 offset:10240
    ds_read_b128 v[108:111], v200 offset:11264
    ds_read_b128 v[112:115], v200 offset:44032
    ds_read_b128 v[116:119], v201 offset:11264
    ds_read_b128 v[120:123], v200 offset:12288
    ds_read_b128 v[124:127], v200 offset:45056
    ds_read_b128 v[128:131], v201 offset:12288
    ds_read_b128 v[132:135], v200 offset:13312
    ds_read_b128 v[136:139], v200 offset:46080
    ds_read_b128 v[140:143], v201 offset:13312
    ds_read_b128 v[144:147], v200 offset:14336
    ds_read_b128 v[148:151], v200 offset:47104
    ds_read_b128 v[152:155], v201 offset:14336
    s_waitcnt lgkmcnt(14)
    v_pk_add_f32 v[28:29], v[28:29], v[96:97]
    v_pk_add_f32 v[30:31], v[30:31], v[98:99]
    s_waitcnt lgkmcnt(13)
    v_pk_add_f32 v[28:29], v[28:29], v[100:101]
    v_pk_add_f32 v[30:31], v[30:31], v[102:103]
    s_waitcnt lgkmcnt(12)
    v_pk_add_f32 v[28:29], v[28:29], v[104:105]
    v_pk_add_f32 v[30:31], v[30:31], v[106:107]
    v_pk_add_f32 v[28:29], v[28:29], v[204:205]
    v_pk_add_f32 v[30:31], v[30:31], v[204:205]
    v_cvt_pk_bf16_f32 v168, v28, v29
    v_cvt_pk_bf16_f32 v169, v30, v31
    buffer_store_dwordx2 v[168:169], v6, s[40:43], s77 offen offset:0 sc0 sc1
    s_waitcnt lgkmcnt(11)
    v_pk_add_f32 v[44:45], v[44:45], v[108:109]
    v_pk_add_f32 v[46:47], v[46:47], v[110:111]
    s_waitcnt lgkmcnt(10)
    v_pk_add_f32 v[44:45], v[44:45], v[112:113]
    v_pk_add_f32 v[46:47], v[46:47], v[114:115]
    s_waitcnt lgkmcnt(9)
    v_pk_add_f32 v[44:45], v[44:45], v[116:117]
    v_pk_add_f32 v[46:47], v[46:47], v[118:119]
    v_pk_add_f32 v[44:45], v[44:45], v[204:205]
    v_pk_add_f32 v[46:47], v[46:47], v[204:205]
    v_cvt_pk_bf16_f32 v160, v44, v45
    v_cvt_pk_bf16_f32 v161, v46, v47
    s_waitcnt lgkmcnt(8)
    v_pk_add_f32 v[60:61], v[60:61], v[120:121]
    v_pk_add_f32 v[62:63], v[62:63], v[122:123]
    s_waitcnt lgkmcnt(7)
    v_pk_add_f32 v[60:61], v[60:61], v[124:125]
    v_pk_add_f32 v[62:63], v[62:63], v[126:127]
    s_waitcnt lgkmcnt(6)
    v_pk_add_f32 v[60:61], v[60:61], v[128:129]
    v_pk_add_f32 v[62:63], v[62:63], v[130:131]
    v_pk_add_f32 v[60:61], v[60:61], v[204:205]
    v_pk_add_f32 v[62:63], v[62:63], v[204:205]
    v_cvt_pk_bf16_f32 v162, v60, v61
    v_cvt_pk_bf16_f32 v163, v62, v63
    s_nop 1
    v_permlane16_swap_b32 v160, v162
    v_permlane16_swap_b32 v161, v163
    buffer_store_dwordx4 v[160:163], v7, s[40:43], s77 offen offset:32 sc0 sc1
    s_waitcnt lgkmcnt(5)
    v_pk_add_f32 v[76:77], v[76:77], v[132:133]
    v_pk_add_f32 v[78:79], v[78:79], v[134:135]
    s_waitcnt lgkmcnt(4)
    v_pk_add_f32 v[76:77], v[76:77], v[136:137]
    v_pk_add_f32 v[78:79], v[78:79], v[138:139]
    s_waitcnt lgkmcnt(3)
    v_pk_add_f32 v[76:77], v[76:77], v[140:141]
    v_pk_add_f32 v[78:79], v[78:79], v[142:143]
    v_pk_add_f32 v[76:77], v[76:77], v[204:205]
    v_pk_add_f32 v[78:79], v[78:79], v[204:205]
    v_cvt_pk_bf16_f32 v164, v76, v77
    v_cvt_pk_bf16_f32 v165, v78, v79
    s_waitcnt lgkmcnt(2)
    v_pk_add_f32 v[92:93], v[92:93], v[144:145]
    v_pk_add_f32 v[94:95], v[94:95], v[146:147]
    s_waitcnt lgkmcnt(1)
    v_pk_add_f32 v[92:93], v[92:93], v[148:149]
    v_pk_add_f32 v[94:95], v[94:95], v[150:151]
    s_waitcnt lgkmcnt(0)
    v_pk_add_f32 v[92:93], v[92:93], v[152:153]
    v_pk_add_f32 v[94:95], v[94:95], v[154:155]
    v_pk_add_f32 v[92:93], v[92:93], v[204:205]
    v_pk_add_f32 v[94:95], v[94:95], v[204:205]
    v_cvt_pk_bf16_f32 v166, v92, v93
    v_cvt_pk_bf16_f32 v167, v94, v95
    s_nop 1
    v_permlane16_swap_b32 v164, v166
    v_permlane16_swap_b32 v165, v167
    buffer_store_dwordx4 v[164:167], v7, s[40:43], s77 offen offset:96 sc0 sc1
    s_branch L_fin
L_fin:
L_done:
    s_endpgm
L_codeend:
.section .rodata,"a"
.p2align 6
.amdhsa_kernel standalone__mixer_token_mlp__prompt_kernel
  .amdhsa_next_free_vgpr 512
  .amdhsa_next_free_sgpr 102
  .amdhsa_accum_offset 256
  .amdhsa_group_segment_fixed_size 0
  .amdhsa_kernarg_size 64
  .amdhsa_user_sgpr_count 2
  .amdhsa_user_sgpr_kernarg_segment_ptr 1
  .amdhsa_system_sgpr_workgroup_id_x 1
  .amdhsa_float_denorm_mode_32 3
.end_amdhsa_kernel
```
